```python
import torch

def _softmax(x, axis=-1):
    return torch.softmax(x, dim=axis)
def _gelu(x):
    return torch.nn.functional.gelu(x, approximate="tanh")
def _silu(x):
    return torch.nn.functional.silu(x)
def _sigmoid(x):
    return torch.sigmoid(x)
def _layernorm(x, axis=-1, eps=1e-5):
    m = x.mean(dim=axis, keepdim=True)
    v = x.var(dim=axis, keepdim=True, unbiased=False)
    return (x - m) / torch.sqrt(v + eps)
def _scatter_add(tgt, idx, src, axis=0):
    return tgt.clone().index_add_(axis, idx, src)
def _segment_sum(src, seg, n):
    out = torch.zeros((n,) + src.shape[1:], dtype=src.dtype)
    return out.index_add_(0, seg, src)
def _pad(x, pw):
    flat = tuple(v for pair in reversed(pw) for v in pair)
    return torch.nn.functional.pad(x, flat)

kernel_name = 'gated_mix__mha_block_cached__glu_gated_geglu__decode'

def setup_inputs():

    _w = (lambda a: (lambda t: t.to(torch.bfloat16) if t.is_floating_point() else t)(torch.as_tensor(a)))
    def _A_setup():
        B, Sq, D = 8, 1, 576
        H, Sk, Dh = 32, 4096, 128
        return {
            "x": _w((lambda *s: torch.randn(*s, dtype=torch.bfloat16) * 0.05)(B, Sq, D)),
            "k_cache": _w((lambda *s: torch.randn(*s, dtype=torch.bfloat16) * 3.2)(B, H, Sk, Dh)),
            "v_cache": _w((lambda *s: torch.randn(*s, dtype=torch.bfloat16) * 0.05)(B, H, Sk, Dh)),
            "wq": _w((lambda *s: torch.randn(*s, dtype=torch.bfloat16) * 3.2)(D, H * Dh) * (D ** -0.5)),
            "wo": _w((lambda *s: torch.randn(*s, dtype=torch.bfloat16) * 0.05)(H * Dh, D) * ((H * Dh) ** -0.5)),
        }
    _A_in = _A_setup()

    def _B_setup():
        B, S, Dm, Df = 8, 1, 576, 4608
        return {
            "x": _w((lambda *s: torch.randn(*s, dtype=torch.bfloat16) * 0.05)(B, S, Dm)),
            "w_gate": _w((lambda *s: torch.randn(*s, dtype=torch.bfloat16) * 0.2)(Dm, Df) * (Dm ** -0.5)),
            "w_up": _w((lambda *s: torch.randn(*s, dtype=torch.bfloat16) * 0.2)(Dm, Df) * (Dm ** -0.5)),
            "w_down": _w((lambda *s: torch.randn(*s, dtype=torch.bfloat16) * 0.2)(Df, Dm) * (Df ** -0.5)),
        }
    _B_in = _B_setup()

    return {
        "A_x": _A_in["x"],
        "A_k_cache": _A_in["k_cache"],
        "A_v_cache": _A_in["v_cache"],
        "A_wq": _A_in["wq"],
        "A_wo": _A_in["wo"],
        "B_x": _B_in["x"],
        "B_w_gate": _B_in["w_gate"],
        "B_w_up": _B_in["w_up"],
        "B_w_down": _B_in["w_down"],
        "gate_w": _w((lambda *s: torch.randn(*s, dtype=torch.bfloat16) * 0.05)(576) * 16.0),
    }

def reference(A_x, A_k_cache, A_v_cache, A_wq, A_wo, B_x, B_w_gate, B_w_up, B_w_down, gate_w):
    def _A_ref(x, k_cache, v_cache, wq, wo):
        B, Sq, D = x.shape
        H, Dh = 32, 128
        q = (lambda x, *d: x.permute(*d))((x @ wq).reshape(B, Sq, H, Dh), 0, 2, 1, 3)
        scores = torch.einsum("bhqd,bhkd->bhqk", q, k_cache) * (Dh ** -0.5)
        p = _softmax(scores, axis=-1)
        o = torch.einsum("bhqk,bhkd->bhqd", p, v_cache)
        return (lambda x, *d: x.permute(*d))(o, 0, 2, 1, 3).reshape(B, Sq, H * Dh) @ wo

    def _B_ref(x, w_gate, w_up, w_down):
        g = torch.einsum("bsd,df->bsf", x, w_gate)
        u = torch.einsum("bsd,df->bsf", x, w_up)
        h = _gelu(g) * u
        return torch.einsum("bsf,fd->bsd", h, w_down)

    x = A_x
    g = _sigmoid((x * gate_w).sum(-1, keepdims=True))
    a = _A_ref(x, A_k_cache, A_v_cache, A_wq, A_wo)
    b = _B_ref(x, B_w_gate, B_w_up, B_w_down)
    return g * a + (1 - g) * b
```

```asm
; @launch grid=(256,1,1) block=(1024,1,1) lds=124288
.amdgcn_target "amdgcn-amd-amdhsa--gfx950"
.text
.globl gated_mix__mha_block_cached__glu_gated_geglu__decode_kernel
.p2align 8
.type gated_mix__mha_block_cached__glu_gated_geglu__decode_kernel,@function
gated_mix__mha_block_cached__glu_gated_geglu__decode_kernel:
    s_cmp_ge_u32 s2, 256
    s_cbranch_scc1 L_done
    s_load_dwordx16 s[36:51], s[0:1], 0
    s_load_dwordx8 s[52:59], s[0:1], 64
    s_load_dwordx2 s[60:61], s[0:1], 96
    v_lshrrev_b32 v17, 6, v0
    v_and_b32 v0, 63, v0
    v_readfirstlane_b32 s3, v17
    s_and_b32 s6, s2, 7
    s_lshr_b32 s7, s2, 3
    s_and_b32 s5, s7, 3
    s_lshl_b32 s6, s6, 2
    s_add_u32 s5, s5, s6
    s_lshr_b32 s4, s7, 2
    s_mov_b32 s96, 0x3db504f3
    s_mov_b32 s97, 0x3fb8aa3b
    s_mov_b32 s99, 0xffff0000
    v_and_b32 v18, 15, v0
    v_lshrrev_b32 v3, 4, v0
    v_lshlrev_b32 v2, 4, v18
    v_lshlrev_b32 v1, 4, v0
    s_lshl_b32 s6, s3, 13
    v_add_u32 v1, s6, v1
    s_mul_i32 s7, s3, 36
    v_min_u32 v19, 8, v18
    v_lshl_add_u32 v19, v19, 2, v3
    v_add_u32 v19, s7, v19
    v_lshlrev_b32 v19, 1, v19
    v_add_u32 v17, s7, v3
    v_lshlrev_b32 v17, 13, v17
    v_add_u32 v17, v17, v2
    s_lshl_b32 s84, s4, 5
    s_add_u32 s84, s84, s5
    s_lshl_b32 s84, s84, 20
    s_mul_i32 s92, s4, 1152
    s_lshl_b32 s93, s5, 8
    s_waitcnt lgkmcnt(0)
    s_add_u32 s64, s36, s92
    s_addc_u32 s65, s37, 0
    s_and_b32 s65, s65, 0xffff
    s_mov_b32 s66, 0x480
    s_mov_b32 s67, 0x20000
    buffer_load_ushort v12, v19, s[64:67], 0 offen
    s_add_u32 s16, s42, s93
    s_addc_u32 s17, s43, 0
    s_and_b32 s17, s17, 0xffff
    s_mov_b32 s18, 0x47e100
    s_mov_b32 s19, 0x20000
    s_mov_b32 s8, s38
    s_and_b32 s9, s39, 0xffff
    s_mov_b32 s10, 0x10000000
    s_mov_b32 s11, 0x20000
    s_mov_b32 s12, s40
    s_and_b32 s13, s41, 0xffff
    s_mov_b32 s14, 0x10000000
    s_mov_b32 s15, 0x20000
    buffer_load_dwordx4 v[56:59], v17, s[16:19], 0 offen
    s_mov_b32 s86, 0x8000
    buffer_load_dwordx4 v[60:63], v17, s[16:19], s86 offen
    s_mov_b32 s86, 0x10000
    buffer_load_dwordx4 v[64:67], v17, s[16:19], s86 offen
    s_mov_b32 s86, 0x18000
    buffer_load_dwordx4 v[68:71], v17, s[16:19], s86 offen
    s_mov_b32 s86, 0x20000
    buffer_load_dwordx4 v[72:75], v17, s[16:19], s86 offen
    s_mov_b32 s86, 0x28000
    buffer_load_dwordx4 v[76:79], v17, s[16:19], s86 offen
    s_mov_b32 s86, 0x30000
    buffer_load_dwordx4 v[80:83], v17, s[16:19], s86 offen
    s_mov_b32 s86, 0x38000
    buffer_load_dwordx4 v[84:87], v17, s[16:19], s86 offen
    s_mov_b32 s86, 0x40000
    buffer_load_dwordx4 v[88:91], v17, s[16:19], s86 offen
    s_add_u32 s85, s84, 0x0
    buffer_load_dwordx4 v[92:95], v1, s[8:11], s85 offen offset:0 nt
    buffer_load_dwordx4 v[96:99], v1, s[8:11], s85 offen offset:1024 nt
    buffer_load_dwordx4 v[100:103], v1, s[8:11], s85 offen offset:2048 nt
    buffer_load_dwordx4 v[104:107], v1, s[8:11], s85 offen offset:3072 nt
    s_add_u32 s85, s84, 0x1000
    buffer_load_dwordx4 v[108:111], v1, s[8:11], s85 offen offset:0 nt
    buffer_load_dwordx4 v[112:115], v1, s[8:11], s85 offen offset:1024 nt
    buffer_load_dwordx4 v[116:119], v1, s[8:11], s85 offen offset:2048 nt
    buffer_load_dwordx4 v[120:123], v1, s[8:11], s85 offen offset:3072 nt
    s_add_u32 s85, s84, 0x0
    buffer_load_dwordx4 v[124:127], v1, s[12:15], s85 offen offset:0 nt
    v_and_b32 v19, 16, v2
    v_mov_b32 v18, 0xffff
    v_lshlrev_b32 v18, v19, v18
    v_lshrrev_b32 v19, 5, v2
    v_cmp_eq_u32 vcc, 0, v19
    s_nop 1
    v_cndmask_b32 v4, 0, v18, vcc
    v_cmp_eq_u32 vcc, 1, v19
    s_nop 1
    v_cndmask_b32 v5, 0, v18, vcc
    v_cmp_eq_u32 vcc, 2, v19
    s_nop 1
    v_cndmask_b32 v6, 0, v18, vcc
    v_cmp_eq_u32 vcc, 3, v19
    s_nop 1
    v_cndmask_b32 v7, 0, v18, vcc
    s_mul_i32 s92, s5, 288
    s_add_u32 s20, s48, s92
    s_addc_u32 s21, s49, 0
    s_and_b32 s21, s21, 0xffff
    s_mov_b32 s22, 0x50dd20
    s_mov_b32 s23, 0x20000
    s_add_u32 s24, s50, s92
    s_addc_u32 s25, s51, 0
    s_and_b32 s25, s25, 0xffff
    s_mov_b32 s26, 0x50dd20
    s_mov_b32 s27, 0x20000
    s_mul_i32 s92, s5, 165888
    s_add_u32 s28, s52, s92
    s_addc_u32 s29, s53, 0
    s_and_b32 s29, s29, 0xffff
    s_mov_b32 s30, 0x28800
    s_mov_b32 s31, 0x20000
    s_mul_i32 s92, s5, 147456
    s_add_u32 s32, s44, s92
    s_addc_u32 s33, s45, 0
    s_and_b32 s33, s33, 0xffff
    s_mov_b32 s34, 0x24000
    s_mov_b32 s35, 0x20000
    s_mov_b32 s68, s54
    s_and_b32 s69, s55, 0xffff
    s_mov_b32 s70, 0x480
    s_mov_b32 s71, 0x20000
    s_mov_b32 s72, s60
    s_and_b32 s73, s61, 0xffff
    s_mov_b32 s74, 0x120000
    s_mov_b32 s75, 0x20000
    s_mov_b32 s76, s56
    s_and_b32 s77, s57, 0xffff
    s_mov_b32 s78, 0x2400
    s_mov_b32 s79, 0x20000
    s_mov_b32 s80, s58
    s_and_b32 s81, s59, 0xffff
    s_mov_b32 s82, 0x100
    s_mov_b32 s83, 0x20000
    s_mul_i32 s94, s4, 9
    s_add_u32 s94, s94, s3
    s_lshl_b32 s98, s94, 6
    s_add_u32 s98, s98, s5
    s_lshl_b32 s98, s98, 8
    v_mov_b32 v19, 0
    ds_write_b32 v19, v19 offset:8448
    ds_write_b32 v19, v19 offset:8452
    v_mov_b32 v13, 0xff7fffff
    v_mov_b32 v14, 0
    v_mov_b32 v20, 0
    v_mov_b32 v21, 0
    v_mov_b32 v22, 0
    v_mov_b32 v23, 0
    s_waitcnt vmcnt(18)
    v_lshl_or_b32 v12, v12, 16, v12
    s_nop 1
    v_and_b32_dpp v24, v12, v4 row_newbcast:0 row_mask:0xf bank_mask:0xf
    v_and_b32_dpp v25, v12, v5 row_newbcast:0 row_mask:0xf bank_mask:0xf
    v_and_b32_dpp v26, v12, v6 row_newbcast:0 row_mask:0xf bank_mask:0xf
    v_and_b32_dpp v27, v12, v7 row_newbcast:0 row_mask:0xf bank_mask:0xf
    s_waitcnt vmcnt(17)
    s_nop 0
    v_mfma_f32_16x16x32_bf16 v[32:35], v[24:27], v[56:59], 0
    buffer_load_dwordx4 v[56:59], v1, s[12:15], s85 offen offset:1024 nt
    v_and_b32_dpp v28, v12, v4 row_newbcast:1 row_mask:0xf bank_mask:0xf
    v_and_b32_dpp v29, v12, v5 row_newbcast:1 row_mask:0xf bank_mask:0xf
    v_and_b32_dpp v30, v12, v6 row_newbcast:1 row_mask:0xf bank_mask:0xf
    v_and_b32_dpp v31, v12, v7 row_newbcast:1 row_mask:0xf bank_mask:0xf
    s_waitcnt vmcnt(17)
    s_nop 0
    v_mfma_f32_16x16x32_bf16 v[32:35], v[28:31], v[60:63], v[32:35]
    buffer_load_dwordx4 v[60:63], v1, s[12:15], s85 offen offset:2048 nt
    v_and_b32_dpp v24, v12, v4 row_newbcast:2 row_mask:0xf bank_mask:0xf
    v_and_b32_dpp v25, v12, v5 row_newbcast:2 row_mask:0xf bank_mask:0xf
    v_and_b32_dpp v26, v12, v6 row_newbcast:2 row_mask:0xf bank_mask:0xf
    v_and_b32_dpp v27, v12, v7 row_newbcast:2 row_mask:0xf bank_mask:0xf
    s_waitcnt vmcnt(17)
    s_nop 0
    v_mfma_f32_16x16x32_bf16 v[32:35], v[24:27], v[64:67], v[32:35]
    buffer_load_dwordx4 v[64:67], v1, s[12:15], s85 offen offset:3072 nt
    v_and_b32_dpp v28, v12, v4 row_newbcast:3 row_mask:0xf bank_mask:0xf
    v_and_b32_dpp v29, v12, v5 row_newbcast:3 row_mask:0xf bank_mask:0xf
    v_and_b32_dpp v30, v12, v6 row_newbcast:3 row_mask:0xf bank_mask:0xf
    v_and_b32_dpp v31, v12, v7 row_newbcast:3 row_mask:0xf bank_mask:0xf
    s_waitcnt vmcnt(17)
    s_nop 0
    v_mfma_f32_16x16x32_bf16 v[32:35], v[28:31], v[68:71], v[32:35]
    s_add_u32 s85, s84, 0x1000
    buffer_load_dwordx4 v[68:71], v1, s[12:15], s85 offen offset:0 nt
    v_and_b32_dpp v24, v12, v4 row_newbcast:4 row_mask:0xf bank_mask:0xf
    v_and_b32_dpp v25, v12, v5 row_newbcast:4 row_mask:0xf bank_mask:0xf
    v_and_b32_dpp v26, v12, v6 row_newbcast:4 row_mask:0xf bank_mask:0xf
    v_and_b32_dpp v27, v12, v7 row_newbcast:4 row_mask:0xf bank_mask:0xf
    s_waitcnt vmcnt(17)
    s_nop 0
    v_mfma_f32_16x16x32_bf16 v[32:35], v[24:27], v[72:75], v[32:35]
    buffer_load_dwordx4 v[72:75], v1, s[12:15], s85 offen offset:1024 nt
    v_and_b32_dpp v28, v12, v4 row_newbcast:5 row_mask:0xf bank_mask:0xf
    v_and_b32_dpp v29, v12, v5 row_newbcast:5 row_mask:0xf bank_mask:0xf
    v_and_b32_dpp v30, v12, v6 row_newbcast:5 row_mask:0xf bank_mask:0xf
    v_and_b32_dpp v31, v12, v7 row_newbcast:5 row_mask:0xf bank_mask:0xf
    s_waitcnt vmcnt(17)
    s_nop 0
    v_mfma_f32_16x16x32_bf16 v[32:35], v[28:31], v[76:79], v[32:35]
    buffer_load_dwordx4 v[76:79], v1, s[12:15], s85 offen offset:2048 nt
    v_and_b32_dpp v24, v12, v4 row_newbcast:6 row_mask:0xf bank_mask:0xf
    v_and_b32_dpp v25, v12, v5 row_newbcast:6 row_mask:0xf bank_mask:0xf
    v_and_b32_dpp v26, v12, v6 row_newbcast:6 row_mask:0xf bank_mask:0xf
    v_and_b32_dpp v27, v12, v7 row_newbcast:6 row_mask:0xf bank_mask:0xf
    s_waitcnt vmcnt(17)
    s_nop 0
    v_mfma_f32_16x16x32_bf16 v[32:35], v[24:27], v[80:83], v[32:35]
    buffer_load_dwordx4 v[80:83], v1, s[12:15], s85 offen offset:3072 nt
    v_and_b32_dpp v28, v12, v4 row_newbcast:7 row_mask:0xf bank_mask:0xf
    v_and_b32_dpp v29, v12, v5 row_newbcast:7 row_mask:0xf bank_mask:0xf
    v_and_b32_dpp v30, v12, v6 row_newbcast:7 row_mask:0xf bank_mask:0xf
    v_and_b32_dpp v31, v12, v7 row_newbcast:7 row_mask:0xf bank_mask:0xf
    s_waitcnt vmcnt(17)
    s_nop 0
    v_mfma_f32_16x16x32_bf16 v[32:35], v[28:31], v[84:87], v[32:35]
    s_add_u32 s85, s84, 0x20000
    buffer_load_dwordx4 v[84:87], v1, s[8:11], s85 offen offset:0 nt
    v_and_b32_dpp v24, v12, v4 row_newbcast:8 row_mask:0xf bank_mask:0xf
    v_and_b32_dpp v25, v12, v5 row_newbcast:8 row_mask:0xf bank_mask:0xf
    v_and_b32_dpp v26, v12, v6 row_newbcast:8 row_mask:0xf bank_mask:0xf
    v_and_b32_dpp v27, v12, v7 row_newbcast:8 row_mask:0xf bank_mask:0xf
    s_waitcnt vmcnt(17)
    s_nop 0
    v_mfma_f32_16x16x32_bf16 v[32:35], v[24:27], v[88:91], v[32:35]
    buffer_load_dwordx4 v[88:91], v1, s[8:11], s85 offen offset:1024 nt
    s_lshl_b32 s6, s3, 9
    v_lshlrev_b32 v18, 1, v2
    v_lshl_add_u32 v18, v3, 4, v18
    v_add_u32 v19, s6, v18
    s_mov_b32 exec_lo, -1
    s_mov_b32 exec_hi, 0
    s_nop 0
    ds_write_b128 v19, v[32:35] offset:0
    s_mov_b64 exec, -1
    s_waitcnt lgkmcnt(0)
    s_barrier
    s_cmp_ge_u32 s3, 2
    s_cbranch_scc1 L_qred_1
    s_lshl_b32 s6, s3, 6
    v_add_u32 v19, s6, v0
    v_lshlrev_b32 v48, 2, v19
    ds_read_b32 v32, v48 offset:0
    ds_read_b32 v33, v48 offset:512
    ds_read_b32 v34, v48 offset:1024
    ds_read_b32 v35, v48 offset:1536
    ds_read_b32 v36, v48 offset:2048
    ds_read_b32 v37, v48 offset:2560
    ds_read_b32 v38, v48 offset:3072
    ds_read_b32 v39, v48 offset:3584
    ds_read_b32 v40, v48 offset:4096
    ds_read_b32 v41, v48 offset:4608
    ds_read_b32 v42, v48 offset:5120
    ds_read_b32 v43, v48 offset:5632
    ds_read_b32 v44, v48 offset:6144
    ds_read_b32 v45, v48 offset:6656
    ds_read_b32 v46, v48 offset:7168
    ds_read_b32 v47, v48 offset:7680
    s_waitcnt lgkmcnt(0)
    v_add_f32 v32, v32, v40
    v_add_f32 v33, v33, v41
    v_add_f32 v34, v34, v42
    v_add_f32 v35, v35, v43
    v_add_f32 v36, v36, v44
    v_add_f32 v37, v37, v45
    v_add_f32 v38, v38, v46
    v_add_f32 v39, v39, v47
    v_add_f32 v32, v32, v36
    v_add_f32 v33, v33, v37
    v_add_f32 v34, v34, v38
    v_add_f32 v35, v35, v39
    v_add_f32 v32, v32, v34
    v_add_f32 v33, v33, v35
    v_add_f32 v32, v32, v33
    v_cvt_pk_bf16_f32 v32, v32, v32
    v_lshlrev_b32 v19, 1, v19
    ds_write_b16 v19, v32 offset:8192
L_qred_1:
    s_waitcnt lgkmcnt(0)
    s_barrier
    ds_read_b128 v[8:11], v2 offset:8192
    s_waitcnt lgkmcnt(0)
    s_waitcnt vmcnt(17)
    v_dot2_f32_bf16 v32, v92, v8, 0
    v_dot2_f32_bf16 v32, v93, v9, v32
    v_dot2_f32_bf16 v32, v94, v10, v32
    v_dot2_f32_bf16 v32, v95, v11, v32
    buffer_load_dwordx4 v[92:95], v1, s[8:11], s85 offen offset:2048 nt
    s_waitcnt vmcnt(17)
    v_dot2_f32_bf16 v33, v96, v8, 0
    v_dot2_f32_bf16 v33, v97, v9, v33
    v_dot2_f32_bf16 v33, v98, v10, v33
    v_dot2_f32_bf16 v33, v99, v11, v33
    buffer_load_dwordx4 v[96:99], v1, s[8:11], s85 offen offset:3072 nt
    s_waitcnt vmcnt(17)
    v_dot2_f32_bf16 v34, v100, v8, 0
    v_dot2_f32_bf16 v34, v101, v9, v34
    v_dot2_f32_bf16 v34, v102, v10, v34
    v_dot2_f32_bf16 v34, v103, v11, v34
    s_add_u32 s85, s84, 0x21000
    buffer_load_dwordx4 v[100:103], v1, s[8:11], s85 offen offset:0 nt
    s_waitcnt vmcnt(17)
    v_dot2_f32_bf16 v35, v104, v8, 0
    v_dot2_f32_bf16 v35, v105, v9, v35
    v_dot2_f32_bf16 v35, v106, v10, v35
    v_dot2_f32_bf16 v35, v107, v11, v35
    buffer_load_dwordx4 v[104:107], v1, s[8:11], s85 offen offset:1024 nt
    s_waitcnt vmcnt(17)
    v_dot2_f32_bf16 v36, v108, v8, 0
    v_dot2_f32_bf16 v36, v109, v9, v36
    v_dot2_f32_bf16 v36, v110, v10, v36
    v_dot2_f32_bf16 v36, v111, v11, v36
    buffer_load_dwordx4 v[108:111], v1, s[8:11], s85 offen offset:2048 nt
    s_waitcnt vmcnt(17)
    v_dot2_f32_bf16 v37, v112, v8, 0
    v_dot2_f32_bf16 v37, v113, v9, v37
    v_dot2_f32_bf16 v37, v114, v10, v37
    v_dot2_f32_bf16 v37, v115, v11, v37
    buffer_load_dwordx4 v[112:115], v1, s[8:11], s85 offen offset:3072 nt
    s_waitcnt vmcnt(17)
    v_dot2_f32_bf16 v38, v116, v8, 0
    v_dot2_f32_bf16 v38, v117, v9, v38
    v_dot2_f32_bf16 v38, v118, v10, v38
    v_dot2_f32_bf16 v38, v119, v11, v38
    s_add_u32 s85, s84, 0x20000
    buffer_load_dwordx4 v[116:119], v1, s[12:15], s85 offen offset:0 nt
    s_waitcnt vmcnt(17)
    v_dot2_f32_bf16 v39, v120, v8, 0
    v_dot2_f32_bf16 v39, v121, v9, v39
    v_dot2_f32_bf16 v39, v122, v10, v39
    v_dot2_f32_bf16 v39, v123, v11, v39
    buffer_load_dwordx4 v[120:123], v1, s[12:15], s85 offen offset:1024 nt
    v_add_f32_dpp v40, v32, v32 row_ror:8 row_mask:0xf bank_mask:0x3
    v_add_f32_dpp v40, v33, v33 row_ror:8 row_mask:0xf bank_mask:0xc
    v_add_f32_dpp v41, v34, v34 row_ror:8 row_mask:0xf bank_mask:0x3
    v_add_f32_dpp v41, v35, v35 row_ror:8 row_mask:0xf bank_mask:0xc
    v_add_f32_dpp v42, v36, v36 row_ror:8 row_mask:0xf bank_mask:0x3
    v_add_f32_dpp v42, v37, v37 row_ror:8 row_mask:0xf bank_mask:0xc
    v_add_f32_dpp v43, v38, v38 row_ror:8 row_mask:0xf bank_mask:0x3
    v_add_f32_dpp v43, v39, v39 row_ror:8 row_mask:0xf bank_mask:0xc
    v_add_f32_dpp v44, v40, v40 row_half_mirror row_mask:0xf bank_mask:0x5
    v_add_f32_dpp v44, v41, v41 row_half_mirror row_mask:0xf bank_mask:0xa
    v_add_f32_dpp v45, v42, v42 row_half_mirror row_mask:0xf bank_mask:0x5
    v_add_f32_dpp v45, v43, v43 row_half_mirror row_mask:0xf bank_mask:0xa
    v_add_f32_dpp v44, v44, v44 quad_perm:[1,0,3,2] row_mask:0xf bank_mask:0xf
    s_nop 0
    v_add_f32_dpp v45, v45, v45 quad_perm:[1,0,3,2] row_mask:0xf bank_mask:0xf
    v_add_f32_dpp v44, v44, v44 quad_perm:[2,3,0,1] row_mask:0xf bank_mask:0xf
    s_nop 0
    v_add_f32_dpp v45, v45, v45 quad_perm:[2,3,0,1] row_mask:0xf bank_mask:0xf
    v_cvt_pk_bf16_f32 v40, v44, v45
    v_lshlrev_b32 v44, 16, v40
    v_and_b32 v45, s99, v40
    v_mul_f32 v44, s96, v44
    v_mul_f32 v45, s96, v45
    v_cvt_pk_bf16_f32 v40, v44, v45
    v_lshlrev_b32 v44, 16, v40
    v_and_b32 v45, s99, v40
    v_max_f32 v46, v44, v45
    s_nop 1
    v_max_f32_dpp v46, v46, v46 row_ror:4 row_mask:0xf bank_mask:0xf
    s_nop 1
    v_max_f32_dpp v46, v46, v46 row_ror:8 row_mask:0xf bank_mask:0xf
    s_nop 0
    v_readlane_b32 s88, v46, 0
    v_readlane_b32 s89, v46, 16
    v_readlane_b32 s90, v46, 32
    v_readlane_b32 s91, v46, 48
    v_max_f32 v46, s88, v13
    v_max_f32 v46, s89, v46
    v_max_f32 v46, s90, v46
    v_max_f32 v46, s91, v46
    v_sub_f32 v47, v13, v46
    v_sub_f32 v44, v44, v46
    v_sub_f32 v45, v45, v46
    v_mul_f32 v47, s97, v47
    v_mul_f32 v44, s97, v44
    v_mul_f32 v45, s97, v45
    v_exp_f32 v47, v47
    v_exp_f32 v44, v44
    v_exp_f32 v45, v45
    v_mov_b32 v13, v46
    v_fma_f32 v14, v14, v47, v44
    v_add_f32 v14, v14, v45
    v_mul_f32 v20, v20, v47
    v_mul_f32 v21, v21, v47
    v_mul_f32 v22, v22, v47
    v_mul_f32 v23, v23, v47
    v_cvt_pk_bf16_f32 v44, v44, v44
    v_cvt_pk_bf16_f32 v45, v45, v45
    s_nop 0
    v_and_b32_dpp v24, v44, v4 row_newbcast:0 row_mask:0xf bank_mask:0xf
    v_and_b32_dpp v25, v44, v5 row_newbcast:0 row_mask:0xf bank_mask:0xf
    v_and_b32_dpp v26, v44, v6 row_newbcast:0 row_mask:0xf bank_mask:0xf
    v_and_b32_dpp v27, v44, v7 row_newbcast:0 row_mask:0xf bank_mask:0xf
    s_waitcnt vmcnt(17)
    s_nop 0
    v_mfma_f32_16x16x32_bf16 v[20:23], v[24:27], v[124:127], v[20:23]
    buffer_load_dwordx4 v[124:127], v1, s[12:15], s85 offen offset:2048 nt
    v_and_b32_dpp v28, v44, v4 row_newbcast:8 row_mask:0xf bank_mask:0xf
    v_and_b32_dpp v29, v44, v5 row_newbcast:8 row_mask:0xf bank_mask:0xf
    v_and_b32_dpp v30, v44, v6 row_newbcast:8 row_mask:0xf bank_mask:0xf
    v_and_b32_dpp v31, v44, v7 row_newbcast:8 row_mask:0xf bank_mask:0xf
    s_waitcnt vmcnt(17)
    s_nop 0
    v_mfma_f32_16x16x32_bf16 v[20:23], v[28:31], v[56:59], v[20:23]
    buffer_load_dwordx4 v[56:59], v1, s[12:15], s85 offen offset:3072 nt
    v_and_b32_dpp v24, v44, v4 row_newbcast:4 row_mask:0xf bank_mask:0xf
    v_and_b32_dpp v25, v44, v5 row_newbcast:4 row_mask:0xf bank_mask:0xf
    v_and_b32_dpp v26, v44, v6 row_newbcast:4 row_mask:0xf bank_mask:0xf
    v_and_b32_dpp v27, v44, v7 row_newbcast:4 row_mask:0xf bank_mask:0xf
    s_waitcnt vmcnt(17)
    s_nop 0
    v_mfma_f32_16x16x32_bf16 v[20:23], v[24:27], v[60:63], v[20:23]
    s_add_u32 s85, s84, 0x21000
    buffer_load_dwordx4 v[60:63], v1, s[12:15], s85 offen offset:0 nt
    v_and_b32_dpp v28, v44, v4 row_newbcast:12 row_mask:0xf bank_mask:0xf
    v_and_b32_dpp v29, v44, v5 row_newbcast:12 row_mask:0xf bank_mask:0xf
    v_and_b32_dpp v30, v44, v6 row_newbcast:12 row_mask:0xf bank_mask:0xf
    v_and_b32_dpp v31, v44, v7 row_newbcast:12 row_mask:0xf bank_mask:0xf
    s_waitcnt vmcnt(17)
    s_nop 0
    v_mfma_f32_16x16x32_bf16 v[20:23], v[28:31], v[64:67], v[20:23]
    buffer_load_dwordx4 v[64:67], v1, s[12:15], s85 offen offset:1024 nt
    v_and_b32_dpp v24, v45, v4 row_newbcast:0 row_mask:0xf bank_mask:0xf
    v_and_b32_dpp v25, v45, v5 row_newbcast:0 row_mask:0xf bank_mask:0xf
    v_and_b32_dpp v26, v45, v6 row_newbcast:0 row_mask:0xf bank_mask:0xf
    v_and_b32_dpp v27, v45, v7 row_newbcast:0 row_mask:0xf bank_mask:0xf
    s_waitcnt vmcnt(17)
    s_nop 0
    v_mfma_f32_16x16x32_bf16 v[20:23], v[24:27], v[68:71], v[20:23]
    buffer_load_dwordx4 v[68:71], v1, s[12:15], s85 offen offset:2048 nt
    v_and_b32_dpp v28, v45, v4 row_newbcast:8 row_mask:0xf bank_mask:0xf
    v_and_b32_dpp v29, v45, v5 row_newbcast:8 row_mask:0xf bank_mask:0xf
    v_and_b32_dpp v30, v45, v6 row_newbcast:8 row_mask:0xf bank_mask:0xf
    v_and_b32_dpp v31, v45, v7 row_newbcast:8 row_mask:0xf bank_mask:0xf
    s_waitcnt vmcnt(17)
    s_nop 0
    v_mfma_f32_16x16x32_bf16 v[20:23], v[28:31], v[72:75], v[20:23]
    buffer_load_dwordx4 v[72:75], v1, s[12:15], s85 offen offset:3072 nt
    v_and_b32_dpp v24, v45, v4 row_newbcast:4 row_mask:0xf bank_mask:0xf
    v_and_b32_dpp v25, v45, v5 row_newbcast:4 row_mask:0xf bank_mask:0xf
    v_and_b32_dpp v26, v45, v6 row_newbcast:4 row_mask:0xf bank_mask:0xf
    v_and_b32_dpp v27, v45, v7 row_newbcast:4 row_mask:0xf bank_mask:0xf
    s_waitcnt vmcnt(17)
    s_nop 0
    v_mfma_f32_16x16x32_bf16 v[20:23], v[24:27], v[76:79], v[20:23]
    s_add_u32 s85, s84, 0x40000
    buffer_load_dwordx4 v[76:79], v1, s[8:11], s85 offen offset:0 nt
    v_and_b32_dpp v28, v45, v4 row_newbcast:12 row_mask:0xf bank_mask:0xf
    v_and_b32_dpp v29, v45, v5 row_newbcast:12 row_mask:0xf bank_mask:0xf
    v_and_b32_dpp v30, v45, v6 row_newbcast:12 row_mask:0xf bank_mask:0xf
    v_and_b32_dpp v31, v45, v7 row_newbcast:12 row_mask:0xf bank_mask:0xf
    s_waitcnt vmcnt(17)
    s_nop 0
    v_mfma_f32_16x16x32_bf16 v[20:23], v[28:31], v[80:83], v[20:23]
    buffer_load_dwordx4 v[80:83], v1, s[8:11], s85 offen offset:1024 nt
    s_waitcnt vmcnt(17)
    v_dot2_f32_bf16 v32, v84, v8, 0
    v_dot2_f32_bf16 v32, v85, v9, v32
    v_dot2_f32_bf16 v32, v86, v10, v32
    v_dot2_f32_bf16 v32, v87, v11, v32
    buffer_load_dwordx4 v[84:87], v1, s[8:11], s85 offen offset:2048 nt
    s_waitcnt vmcnt(17)
    v_dot2_f32_bf16 v33, v88, v8, 0
    v_dot2_f32_bf16 v33, v89, v9, v33
    v_dot2_f32_bf16 v33, v90, v10, v33
    v_dot2_f32_bf16 v33, v91, v11, v33
    buffer_load_dwordx4 v[88:91], v1, s[8:11], s85 offen offset:3072 nt
    s_waitcnt vmcnt(17)
    v_dot2_f32_bf16 v34, v92, v8, 0
    v_dot2_f32_bf16 v34, v93, v9, v34
    v_dot2_f32_bf16 v34, v94, v10, v34
    v_dot2_f32_bf16 v34, v95, v11, v34
    s_add_u32 s85, s84, 0x41000
    buffer_load_dwordx4 v[92:95], v1, s[8:11], s85 offen offset:0 nt
    s_waitcnt vmcnt(17)
    v_dot2_f32_bf16 v35, v96, v8, 0
    v_dot2_f32_bf16 v35, v97, v9, v35
    v_dot2_f32_bf16 v35, v98, v10, v35
    v_dot2_f32_bf16 v35, v99, v11, v35
    buffer_load_dwordx4 v[96:99], v1, s[8:11], s85 offen offset:1024 nt
    s_waitcnt vmcnt(17)
    v_dot2_f32_bf16 v36, v100, v8, 0
    v_dot2_f32_bf16 v36, v101, v9, v36
    v_dot2_f32_bf16 v36, v102, v10, v36
    v_dot2_f32_bf16 v36, v103, v11, v36
    buffer_load_dwordx4 v[100:103], v1, s[8:11], s85 offen offset:2048 nt
    s_waitcnt vmcnt(17)
    v_dot2_f32_bf16 v37, v104, v8, 0
    v_dot2_f32_bf16 v37, v105, v9, v37
    v_dot2_f32_bf16 v37, v106, v10, v37
    v_dot2_f32_bf16 v37, v107, v11, v37
    buffer_load_dwordx4 v[104:107], v1, s[8:11], s85 offen offset:3072 nt
    s_waitcnt vmcnt(17)
    v_dot2_f32_bf16 v38, v108, v8, 0
    v_dot2_f32_bf16 v38, v109, v9, v38
    v_dot2_f32_bf16 v38, v110, v10, v38
    v_dot2_f32_bf16 v38, v111, v11, v38
    s_add_u32 s85, s84, 0x40000
    buffer_load_dwordx4 v[108:111], v1, s[12:15], s85 offen offset:0 nt
    s_waitcnt vmcnt(17)
    v_dot2_f32_bf16 v39, v112, v8, 0
    v_dot2_f32_bf16 v39, v113, v9, v39
    v_dot2_f32_bf16 v39, v114, v10, v39
    v_dot2_f32_bf16 v39, v115, v11, v39
    buffer_load_dwordx4 v[112:115], v1, s[12:15], s85 offen offset:1024 nt
    v_add_f32_dpp v40, v32, v32 row_ror:8 row_mask:0xf bank_mask:0x3
    v_add_f32_dpp v40, v33, v33 row_ror:8 row_mask:0xf bank_mask:0xc
    v_add_f32_dpp v41, v34, v34 row_ror:8 row_mask:0xf bank_mask:0x3
    v_add_f32_dpp v41, v35, v35 row_ror:8 row_mask:0xf bank_mask:0xc
    v_add_f32_dpp v42, v36, v36 row_ror:8 row_mask:0xf bank_mask:0x3
    v_add_f32_dpp v42, v37, v37 row_ror:8 row_mask:0xf bank_mask:0xc
    v_add_f32_dpp v43, v38, v38 row_ror:8 row_mask:0xf bank_mask:0x3
    v_add_f32_dpp v43, v39, v39 row_ror:8 row_mask:0xf bank_mask:0xc
    v_add_f32_dpp v44, v40, v40 row_half_mirror row_mask:0xf bank_mask:0x5
    v_add_f32_dpp v44, v41, v41 row_half_mirror row_mask:0xf bank_mask:0xa
    v_add_f32_dpp v45, v42, v42 row_half_mirror row_mask:0xf bank_mask:0x5
    v_add_f32_dpp v45, v43, v43 row_half_mirror row_mask:0xf bank_mask:0xa
    v_add_f32_dpp v44, v44, v44 quad_perm:[1,0,3,2] row_mask:0xf bank_mask:0xf
    s_nop 0
    v_add_f32_dpp v45, v45, v45 quad_perm:[1,0,3,2] row_mask:0xf bank_mask:0xf
    v_add_f32_dpp v44, v44, v44 quad_perm:[2,3,0,1] row_mask:0xf bank_mask:0xf
    s_nop 0
    v_add_f32_dpp v45, v45, v45 quad_perm:[2,3,0,1] row_mask:0xf bank_mask:0xf
    v_cvt_pk_bf16_f32 v40, v44, v45
    v_lshlrev_b32 v44, 16, v40
    v_and_b32 v45, s99, v40
    v_mul_f32 v44, s96, v44
    v_mul_f32 v45, s96, v45
    v_cvt_pk_bf16_f32 v40, v44, v45
    v_lshlrev_b32 v44, 16, v40
    v_and_b32 v45, s99, v40
    v_max_f32 v46, v44, v45
    s_nop 1
    v_max_f32_dpp v46, v46, v46 row_ror:4 row_mask:0xf bank_mask:0xf
    s_nop 1
    v_max_f32_dpp v46, v46, v46 row_ror:8 row_mask:0xf bank_mask:0xf
    s_nop 0
    v_readlane_b32 s88, v46, 0
    v_readlane_b32 s89, v46, 16
    v_readlane_b32 s90, v46, 32
    v_readlane_b32 s91, v46, 48
    v_max_f32 v46, s88, v13
    v_max_f32 v46, s89, v46
    v_max_f32 v46, s90, v46
    v_max_f32 v46, s91, v46
    v_sub_f32 v47, v13, v46
    v_sub_f32 v44, v44, v46
    v_sub_f32 v45, v45, v46
    v_mul_f32 v47, s97, v47
    v_mul_f32 v44, s97, v44
    v_mul_f32 v45, s97, v45
    v_exp_f32 v47, v47
    v_exp_f32 v44, v44
    v_exp_f32 v45, v45
    v_mov_b32 v13, v46
    v_fma_f32 v14, v14, v47, v44
    v_add_f32 v14, v14, v45
    v_mul_f32 v20, v20, v47
    v_mul_f32 v21, v21, v47
    v_mul_f32 v22, v22, v47
    v_mul_f32 v23, v23, v47
    v_cvt_pk_bf16_f32 v44, v44, v44
    v_cvt_pk_bf16_f32 v45, v45, v45
    s_nop 0
    v_and_b32_dpp v24, v44, v4 row_newbcast:0 row_mask:0xf bank_mask:0xf
    v_and_b32_dpp v25, v44, v5 row_newbcast:0 row_mask:0xf bank_mask:0xf
    v_and_b32_dpp v26, v44, v6 row_newbcast:0 row_mask:0xf bank_mask:0xf
    v_and_b32_dpp v27, v44, v7 row_newbcast:0 row_mask:0xf bank_mask:0xf
    s_waitcnt vmcnt(17)
    s_nop 0
    v_mfma_f32_16x16x32_bf16 v[20:23], v[24:27], v[116:119], v[20:23]
    buffer_load_dwordx4 v[116:119], v1, s[12:15], s85 offen offset:2048 nt
    v_and_b32_dpp v28, v44, v4 row_newbcast:8 row_mask:0xf bank_mask:0xf
    v_and_b32_dpp v29, v44, v5 row_newbcast:8 row_mask:0xf bank_mask:0xf
    v_and_b32_dpp v30, v44, v6 row_newbcast:8 row_mask:0xf bank_mask:0xf
    v_and_b32_dpp v31, v44, v7 row_newbcast:8 row_mask:0xf bank_mask:0xf
    s_waitcnt vmcnt(17)
    s_nop 0
    v_mfma_f32_16x16x32_bf16 v[20:23], v[28:31], v[120:123], v[20:23]
    buffer_load_dwordx4 v[120:123], v1, s[12:15], s85 offen offset:3072 nt
    v_and_b32_dpp v24, v44, v4 row_newbcast:4 row_mask:0xf bank_mask:0xf
    v_and_b32_dpp v25, v44, v5 row_newbcast:4 row_mask:0xf bank_mask:0xf
    v_and_b32_dpp v26, v44, v6 row_newbcast:4 row_mask:0xf bank_mask:0xf
    v_and_b32_dpp v27, v44, v7 row_newbcast:4 row_mask:0xf bank_mask:0xf
    s_waitcnt vmcnt(17)
    s_nop 0
    v_mfma_f32_16x16x32_bf16 v[20:23], v[24:27], v[124:127], v[20:23]
    s_add_u32 s85, s84, 0x41000
    buffer_load_dwordx4 v[124:127], v1, s[12:15], s85 offen offset:0 nt
    v_and_b32_dpp v28, v44, v4 row_newbcast:12 row_mask:0xf bank_mask:0xf
    v_and_b32_dpp v29, v44, v5 row_newbcast:12 row_mask:0xf bank_mask:0xf
    v_and_b32_dpp v30, v44, v6 row_newbcast:12 row_mask:0xf bank_mask:0xf
    v_and_b32_dpp v31, v44, v7 row_newbcast:12 row_mask:0xf bank_mask:0xf
    s_waitcnt vmcnt(17)
    s_nop 0
    v_mfma_f32_16x16x32_bf16 v[20:23], v[28:31], v[56:59], v[20:23]
    buffer_load_dwordx4 v[56:59], v1, s[12:15], s85 offen offset:1024 nt
    v_and_b32_dpp v24, v45, v4 row_newbcast:0 row_mask:0xf bank_mask:0xf
    v_and_b32_dpp v25, v45, v5 row_newbcast:0 row_mask:0xf bank_mask:0xf
    v_and_b32_dpp v26, v45, v6 row_newbcast:0 row_mask:0xf bank_mask:0xf
    v_and_b32_dpp v27, v45, v7 row_newbcast:0 row_mask:0xf bank_mask:0xf
    s_waitcnt vmcnt(17)
    s_nop 0
    v_mfma_f32_16x16x32_bf16 v[20:23], v[24:27], v[60:63], v[20:23]
    buffer_load_dwordx4 v[60:63], v1, s[12:15], s85 offen offset:2048 nt
    v_and_b32_dpp v28, v45, v4 row_newbcast:8 row_mask:0xf bank_mask:0xf
    v_and_b32_dpp v29, v45, v5 row_newbcast:8 row_mask:0xf bank_mask:0xf
    v_and_b32_dpp v30, v45, v6 row_newbcast:8 row_mask:0xf bank_mask:0xf
    v_and_b32_dpp v31, v45, v7 row_newbcast:8 row_mask:0xf bank_mask:0xf
    s_waitcnt vmcnt(17)
    s_nop 0
    v_mfma_f32_16x16x32_bf16 v[20:23], v[28:31], v[64:67], v[20:23]
    buffer_load_dwordx4 v[64:67], v1, s[12:15], s85 offen offset:3072 nt
    v_and_b32_dpp v24, v45, v4 row_newbcast:4 row_mask:0xf bank_mask:0xf
    v_and_b32_dpp v25, v45, v5 row_newbcast:4 row_mask:0xf bank_mask:0xf
    v_and_b32_dpp v26, v45, v6 row_newbcast:4 row_mask:0xf bank_mask:0xf
    v_and_b32_dpp v27, v45, v7 row_newbcast:4 row_mask:0xf bank_mask:0xf
    s_waitcnt vmcnt(17)
    s_nop 0
    v_mfma_f32_16x16x32_bf16 v[20:23], v[24:27], v[68:71], v[20:23]
    s_add_u32 s85, s84, 0x60000
    buffer_load_dwordx4 v[68:71], v1, s[8:11], s85 offen offset:0 nt
    v_and_b32_dpp v28, v45, v4 row_newbcast:12 row_mask:0xf bank_mask:0xf
    v_and_b32_dpp v29, v45, v5 row_newbcast:12 row_mask:0xf bank_mask:0xf
    v_and_b32_dpp v30, v45, v6 row_newbcast:12 row_mask:0xf bank_mask:0xf
    v_and_b32_dpp v31, v45, v7 row_newbcast:12 row_mask:0xf bank_mask:0xf
    s_waitcnt vmcnt(17)
    s_nop 0
    v_mfma_f32_16x16x32_bf16 v[20:23], v[28:31], v[72:75], v[20:23]
    buffer_load_dwordx4 v[72:75], v1, s[8:11], s85 offen offset:1024 nt
    s_waitcnt vmcnt(17)
    v_dot2_f32_bf16 v32, v76, v8, 0
    v_dot2_f32_bf16 v32, v77, v9, v32
    v_dot2_f32_bf16 v32, v78, v10, v32
    v_dot2_f32_bf16 v32, v79, v11, v32
    buffer_load_dwordx4 v[76:79], v1, s[8:11], s85 offen offset:2048 nt
    s_waitcnt vmcnt(17)
    v_dot2_f32_bf16 v33, v80, v8, 0
    v_dot2_f32_bf16 v33, v81, v9, v33
    v_dot2_f32_bf16 v33, v82, v10, v33
    v_dot2_f32_bf16 v33, v83, v11, v33
    buffer_load_dwordx4 v[80:83], v1, s[8:11], s85 offen offset:3072 nt
    s_waitcnt vmcnt(17)
    v_dot2_f32_bf16 v34, v84, v8, 0
    v_dot2_f32_bf16 v34, v85, v9, v34
    v_dot2_f32_bf16 v34, v86, v10, v34
    v_dot2_f32_bf16 v34, v87, v11, v34
    s_add_u32 s85, s84, 0x61000
    buffer_load_dwordx4 v[84:87], v1, s[8:11], s85 offen offset:0 nt
    s_waitcnt vmcnt(17)
    v_dot2_f32_bf16 v35, v88, v8, 0
    v_dot2_f32_bf16 v35, v89, v9, v35
    v_dot2_f32_bf16 v35, v90, v10, v35
    v_dot2_f32_bf16 v35, v91, v11, v35
    buffer_load_dwordx4 v[88:91], v1, s[8:11], s85 offen offset:1024 nt
    s_waitcnt vmcnt(17)
    v_dot2_f32_bf16 v36, v92, v8, 0
    v_dot2_f32_bf16 v36, v93, v9, v36
    v_dot2_f32_bf16 v36, v94, v10, v36
    v_dot2_f32_bf16 v36, v95, v11, v36
    buffer_load_dwordx4 v[92:95], v1, s[8:11], s85 offen offset:2048 nt
    s_waitcnt vmcnt(17)
    v_dot2_f32_bf16 v37, v96, v8, 0
    v_dot2_f32_bf16 v37, v97, v9, v37
    v_dot2_f32_bf16 v37, v98, v10, v37
    v_dot2_f32_bf16 v37, v99, v11, v37
    buffer_load_dwordx4 v[96:99], v1, s[8:11], s85 offen offset:3072 nt
    s_waitcnt vmcnt(17)
    v_dot2_f32_bf16 v38, v100, v8, 0
    v_dot2_f32_bf16 v38, v101, v9, v38
    v_dot2_f32_bf16 v38, v102, v10, v38
    v_dot2_f32_bf16 v38, v103, v11, v38
    s_add_u32 s85, s84, 0x60000
    buffer_load_dwordx4 v[100:103], v1, s[12:15], s85 offen offset:0 nt
    s_waitcnt vmcnt(17)
    v_dot2_f32_bf16 v39, v104, v8, 0
    v_dot2_f32_bf16 v39, v105, v9, v39
    v_dot2_f32_bf16 v39, v106, v10, v39
    v_dot2_f32_bf16 v39, v107, v11, v39
    buffer_load_dwordx4 v[104:107], v1, s[12:15], s85 offen offset:1024 nt
    v_add_f32_dpp v40, v32, v32 row_ror:8 row_mask:0xf bank_mask:0x3
    v_add_f32_dpp v40, v33, v33 row_ror:8 row_mask:0xf bank_mask:0xc
    v_add_f32_dpp v41, v34, v34 row_ror:8 row_mask:0xf bank_mask:0x3
    v_add_f32_dpp v41, v35, v35 row_ror:8 row_mask:0xf bank_mask:0xc
    v_add_f32_dpp v42, v36, v36 row_ror:8 row_mask:0xf bank_mask:0x3
    v_add_f32_dpp v42, v37, v37 row_ror:8 row_mask:0xf bank_mask:0xc
    v_add_f32_dpp v43, v38, v38 row_ror:8 row_mask:0xf bank_mask:0x3
    v_add_f32_dpp v43, v39, v39 row_ror:8 row_mask:0xf bank_mask:0xc
    v_add_f32_dpp v44, v40, v40 row_half_mirror row_mask:0xf bank_mask:0x5
    v_add_f32_dpp v44, v41, v41 row_half_mirror row_mask:0xf bank_mask:0xa
    v_add_f32_dpp v45, v42, v42 row_half_mirror row_mask:0xf bank_mask:0x5
    v_add_f32_dpp v45, v43, v43 row_half_mirror row_mask:0xf bank_mask:0xa
    v_add_f32_dpp v44, v44, v44 quad_perm:[1,0,3,2] row_mask:0xf bank_mask:0xf
    s_nop 0
    v_add_f32_dpp v45, v45, v45 quad_perm:[1,0,3,2] row_mask:0xf bank_mask:0xf
    v_add_f32_dpp v44, v44, v44 quad_perm:[2,3,0,1] row_mask:0xf bank_mask:0xf
    s_nop 0
    v_add_f32_dpp v45, v45, v45 quad_perm:[2,3,0,1] row_mask:0xf bank_mask:0xf
    v_cvt_pk_bf16_f32 v40, v44, v45
    v_lshlrev_b32 v44, 16, v40
    v_and_b32 v45, s99, v40
    v_mul_f32 v44, s96, v44
    v_mul_f32 v45, s96, v45
    v_cvt_pk_bf16_f32 v40, v44, v45
    v_lshlrev_b32 v44, 16, v40
    v_and_b32 v45, s99, v40
    v_max_f32 v46, v44, v45
    s_nop 1
    v_max_f32_dpp v46, v46, v46 row_ror:4 row_mask:0xf bank_mask:0xf
    s_nop 1
    v_max_f32_dpp v46, v46, v46 row_ror:8 row_mask:0xf bank_mask:0xf
    s_nop 0
    v_readlane_b32 s88, v46, 0
    v_readlane_b32 s89, v46, 16
    v_readlane_b32 s90, v46, 32
    v_readlane_b32 s91, v46, 48
    v_max_f32 v46, s88, v13
    v_max_f32 v46, s89, v46
    v_max_f32 v46, s90, v46
    v_max_f32 v46, s91, v46
    v_sub_f32 v47, v13, v46
    v_sub_f32 v44, v44, v46
    v_sub_f32 v45, v45, v46
    v_mul_f32 v47, s97, v47
    v_mul_f32 v44, s97, v44
    v_mul_f32 v45, s97, v45
    v_exp_f32 v47, v47
    v_exp_f32 v44, v44
    v_exp_f32 v45, v45
    v_mov_b32 v13, v46
    v_fma_f32 v14, v14, v47, v44
    v_add_f32 v14, v14, v45
    v_mul_f32 v20, v20, v47
    v_mul_f32 v21, v21, v47
    v_mul_f32 v22, v22, v47
    v_mul_f32 v23, v23, v47
    v_cvt_pk_bf16_f32 v44, v44, v44
    v_cvt_pk_bf16_f32 v45, v45, v45
    s_nop 0
    v_and_b32_dpp v24, v44, v4 row_newbcast:0 row_mask:0xf bank_mask:0xf
    v_and_b32_dpp v25, v44, v5 row_newbcast:0 row_mask:0xf bank_mask:0xf
    v_and_b32_dpp v26, v44, v6 row_newbcast:0 row_mask:0xf bank_mask:0xf
    v_and_b32_dpp v27, v44, v7 row_newbcast:0 row_mask:0xf bank_mask:0xf
    s_waitcnt vmcnt(17)
    s_nop 0
    v_mfma_f32_16x16x32_bf16 v[20:23], v[24:27], v[108:111], v[20:23]
    buffer_load_dwordx4 v[108:111], v1, s[12:15], s85 offen offset:2048 nt
    v_and_b32_dpp v28, v44, v4 row_newbcast:8 row_mask:0xf bank_mask:0xf
    v_and_b32_dpp v29, v44, v5 row_newbcast:8 row_mask:0xf bank_mask:0xf
    v_and_b32_dpp v30, v44, v6 row_newbcast:8 row_mask:0xf bank_mask:0xf
    v_and_b32_dpp v31, v44, v7 row_newbcast:8 row_mask:0xf bank_mask:0xf
    s_waitcnt vmcnt(17)
    s_nop 0
    v_mfma_f32_16x16x32_bf16 v[20:23], v[28:31], v[112:115], v[20:23]
    buffer_load_dwordx4 v[112:115], v1, s[12:15], s85 offen offset:3072 nt
    v_and_b32_dpp v24, v44, v4 row_newbcast:4 row_mask:0xf bank_mask:0xf
    v_and_b32_dpp v25, v44, v5 row_newbcast:4 row_mask:0xf bank_mask:0xf
    v_and_b32_dpp v26, v44, v6 row_newbcast:4 row_mask:0xf bank_mask:0xf
    v_and_b32_dpp v27, v44, v7 row_newbcast:4 row_mask:0xf bank_mask:0xf
    s_waitcnt vmcnt(17)
    s_nop 0
    v_mfma_f32_16x16x32_bf16 v[20:23], v[24:27], v[116:119], v[20:23]
    s_add_u32 s85, s84, 0x61000
    buffer_load_dwordx4 v[116:119], v1, s[12:15], s85 offen offset:0 nt
    v_and_b32_dpp v28, v44, v4 row_newbcast:12 row_mask:0xf bank_mask:0xf
    v_and_b32_dpp v29, v44, v5 row_newbcast:12 row_mask:0xf bank_mask:0xf
    v_and_b32_dpp v30, v44, v6 row_newbcast:12 row_mask:0xf bank_mask:0xf
    v_and_b32_dpp v31, v44, v7 row_newbcast:12 row_mask:0xf bank_mask:0xf
    s_waitcnt vmcnt(17)
    s_nop 0
    v_mfma_f32_16x16x32_bf16 v[20:23], v[28:31], v[120:123], v[20:23]
    buffer_load_dwordx4 v[120:123], v1, s[12:15], s85 offen offset:1024 nt
    v_and_b32_dpp v24, v45, v4 row_newbcast:0 row_mask:0xf bank_mask:0xf
    v_and_b32_dpp v25, v45, v5 row_newbcast:0 row_mask:0xf bank_mask:0xf
    v_and_b32_dpp v26, v45, v6 row_newbcast:0 row_mask:0xf bank_mask:0xf
    v_and_b32_dpp v27, v45, v7 row_newbcast:0 row_mask:0xf bank_mask:0xf
    s_waitcnt vmcnt(17)
    s_nop 0
    v_mfma_f32_16x16x32_bf16 v[20:23], v[24:27], v[124:127], v[20:23]
    buffer_load_dwordx4 v[124:127], v1, s[12:15], s85 offen offset:2048 nt
    v_and_b32_dpp v28, v45, v4 row_newbcast:8 row_mask:0xf bank_mask:0xf
    v_and_b32_dpp v29, v45, v5 row_newbcast:8 row_mask:0xf bank_mask:0xf
    v_and_b32_dpp v30, v45, v6 row_newbcast:8 row_mask:0xf bank_mask:0xf
    v_and_b32_dpp v31, v45, v7 row_newbcast:8 row_mask:0xf bank_mask:0xf
    s_waitcnt vmcnt(17)
    s_nop 0
    v_mfma_f32_16x16x32_bf16 v[20:23], v[28:31], v[56:59], v[20:23]
    buffer_load_dwordx4 v[56:59], v1, s[12:15], s85 offen offset:3072 nt
    v_and_b32_dpp v24, v45, v4 row_newbcast:4 row_mask:0xf bank_mask:0xf
    v_and_b32_dpp v25, v45, v5 row_newbcast:4 row_mask:0xf bank_mask:0xf
    v_and_b32_dpp v26, v45, v6 row_newbcast:4 row_mask:0xf bank_mask:0xf
    v_and_b32_dpp v27, v45, v7 row_newbcast:4 row_mask:0xf bank_mask:0xf
    s_waitcnt vmcnt(17)
    s_nop 0
    v_mfma_f32_16x16x32_bf16 v[20:23], v[24:27], v[60:63], v[20:23]
    s_add_u32 s85, s84, 0x80000
    buffer_load_dwordx4 v[60:63], v1, s[8:11], s85 offen offset:0 nt
    v_and_b32_dpp v28, v45, v4 row_newbcast:12 row_mask:0xf bank_mask:0xf
    v_and_b32_dpp v29, v45, v5 row_newbcast:12 row_mask:0xf bank_mask:0xf
    v_and_b32_dpp v30, v45, v6 row_newbcast:12 row_mask:0xf bank_mask:0xf
    v_and_b32_dpp v31, v45, v7 row_newbcast:12 row_mask:0xf bank_mask:0xf
    s_waitcnt vmcnt(17)
    s_nop 0
    v_mfma_f32_16x16x32_bf16 v[20:23], v[28:31], v[64:67], v[20:23]
    buffer_load_dwordx4 v[64:67], v1, s[8:11], s85 offen offset:1024 nt
    s_waitcnt vmcnt(17)
    v_dot2_f32_bf16 v32, v68, v8, 0
    v_dot2_f32_bf16 v32, v69, v9, v32
    v_dot2_f32_bf16 v32, v70, v10, v32
    v_dot2_f32_bf16 v32, v71, v11, v32
    buffer_load_dwordx4 v[68:71], v1, s[8:11], s85 offen offset:2048 nt
    s_waitcnt vmcnt(17)
    v_dot2_f32_bf16 v33, v72, v8, 0
    v_dot2_f32_bf16 v33, v73, v9, v33
    v_dot2_f32_bf16 v33, v74, v10, v33
    v_dot2_f32_bf16 v33, v75, v11, v33
    buffer_load_dwordx4 v[72:75], v1, s[8:11], s85 offen offset:3072 nt
    s_waitcnt vmcnt(17)
    v_dot2_f32_bf16 v34, v76, v8, 0
    v_dot2_f32_bf16 v34, v77, v9, v34
    v_dot2_f32_bf16 v34, v78, v10, v34
    v_dot2_f32_bf16 v34, v79, v11, v34
    s_add_u32 s85, s84, 0x81000
    buffer_load_dwordx4 v[76:79], v1, s[8:11], s85 offen offset:0 nt
    s_waitcnt vmcnt(17)
    v_dot2_f32_bf16 v35, v80, v8, 0
    v_dot2_f32_bf16 v35, v81, v9, v35
    v_dot2_f32_bf16 v35, v82, v10, v35
    v_dot2_f32_bf16 v35, v83, v11, v35
    buffer_load_dwordx4 v[80:83], v1, s[8:11], s85 offen offset:1024 nt
    s_waitcnt vmcnt(17)
    v_dot2_f32_bf16 v36, v84, v8, 0
    v_dot2_f32_bf16 v36, v85, v9, v36
    v_dot2_f32_bf16 v36, v86, v10, v36
    v_dot2_f32_bf16 v36, v87, v11, v36
    buffer_load_dwordx4 v[84:87], v1, s[8:11], s85 offen offset:2048 nt
    s_waitcnt vmcnt(17)
    v_dot2_f32_bf16 v37, v88, v8, 0
    v_dot2_f32_bf16 v37, v89, v9, v37
    v_dot2_f32_bf16 v37, v90, v10, v37
    v_dot2_f32_bf16 v37, v91, v11, v37
    buffer_load_dwordx4 v[88:91], v1, s[8:11], s85 offen offset:3072 nt
    s_waitcnt vmcnt(17)
    v_dot2_f32_bf16 v38, v92, v8, 0
    v_dot2_f32_bf16 v38, v93, v9, v38
    v_dot2_f32_bf16 v38, v94, v10, v38
    v_dot2_f32_bf16 v38, v95, v11, v38
    s_add_u32 s85, s84, 0x80000
    buffer_load_dwordx4 v[92:95], v1, s[12:15], s85 offen offset:0 nt
    s_waitcnt vmcnt(17)
    v_dot2_f32_bf16 v39, v96, v8, 0
    v_dot2_f32_bf16 v39, v97, v9, v39
    v_dot2_f32_bf16 v39, v98, v10, v39
    v_dot2_f32_bf16 v39, v99, v11, v39
    buffer_load_dwordx4 v[96:99], v1, s[12:15], s85 offen offset:1024 nt
    v_add_f32_dpp v40, v32, v32 row_ror:8 row_mask:0xf bank_mask:0x3
    v_add_f32_dpp v40, v33, v33 row_ror:8 row_mask:0xf bank_mask:0xc
    v_add_f32_dpp v41, v34, v34 row_ror:8 row_mask:0xf bank_mask:0x3
    v_add_f32_dpp v41, v35, v35 row_ror:8 row_mask:0xf bank_mask:0xc
    v_add_f32_dpp v42, v36, v36 row_ror:8 row_mask:0xf bank_mask:0x3
    v_add_f32_dpp v42, v37, v37 row_ror:8 row_mask:0xf bank_mask:0xc
    v_add_f32_dpp v43, v38, v38 row_ror:8 row_mask:0xf bank_mask:0x3
    v_add_f32_dpp v43, v39, v39 row_ror:8 row_mask:0xf bank_mask:0xc
    v_add_f32_dpp v44, v40, v40 row_half_mirror row_mask:0xf bank_mask:0x5
    v_add_f32_dpp v44, v41, v41 row_half_mirror row_mask:0xf bank_mask:0xa
    v_add_f32_dpp v45, v42, v42 row_half_mirror row_mask:0xf bank_mask:0x5
    v_add_f32_dpp v45, v43, v43 row_half_mirror row_mask:0xf bank_mask:0xa
    v_add_f32_dpp v44, v44, v44 quad_perm:[1,0,3,2] row_mask:0xf bank_mask:0xf
    s_nop 0
    v_add_f32_dpp v45, v45, v45 quad_perm:[1,0,3,2] row_mask:0xf bank_mask:0xf
    v_add_f32_dpp v44, v44, v44 quad_perm:[2,3,0,1] row_mask:0xf bank_mask:0xf
    s_nop 0
    v_add_f32_dpp v45, v45, v45 quad_perm:[2,3,0,1] row_mask:0xf bank_mask:0xf
    v_cvt_pk_bf16_f32 v40, v44, v45
    v_lshlrev_b32 v44, 16, v40
    v_and_b32 v45, s99, v40
    v_mul_f32 v44, s96, v44
    v_mul_f32 v45, s96, v45
    v_cvt_pk_bf16_f32 v40, v44, v45
    v_lshlrev_b32 v44, 16, v40
    v_and_b32 v45, s99, v40
    v_max_f32 v46, v44, v45
    s_nop 1
    v_max_f32_dpp v46, v46, v46 row_ror:4 row_mask:0xf bank_mask:0xf
    s_nop 1
    v_max_f32_dpp v46, v46, v46 row_ror:8 row_mask:0xf bank_mask:0xf
    s_nop 0
    v_readlane_b32 s88, v46, 0
    v_readlane_b32 s89, v46, 16
    v_readlane_b32 s90, v46, 32
    v_readlane_b32 s91, v46, 48
    v_max_f32 v46, s88, v13
    v_max_f32 v46, s89, v46
    v_max_f32 v46, s90, v46
    v_max_f32 v46, s91, v46
    v_sub_f32 v47, v13, v46
    v_sub_f32 v44, v44, v46
    v_sub_f32 v45, v45, v46
    v_mul_f32 v47, s97, v47
    v_mul_f32 v44, s97, v44
    v_mul_f32 v45, s97, v45
    v_exp_f32 v47, v47
    v_exp_f32 v44, v44
    v_exp_f32 v45, v45
    v_mov_b32 v13, v46
    v_fma_f32 v14, v14, v47, v44
    v_add_f32 v14, v14, v45
    v_mul_f32 v20, v20, v47
    v_mul_f32 v21, v21, v47
    v_mul_f32 v22, v22, v47
    v_mul_f32 v23, v23, v47
    v_cvt_pk_bf16_f32 v44, v44, v44
    v_cvt_pk_bf16_f32 v45, v45, v45
    s_nop 0
    v_and_b32_dpp v24, v44, v4 row_newbcast:0 row_mask:0xf bank_mask:0xf
    v_and_b32_dpp v25, v44, v5 row_newbcast:0 row_mask:0xf bank_mask:0xf
    v_and_b32_dpp v26, v44, v6 row_newbcast:0 row_mask:0xf bank_mask:0xf
    v_and_b32_dpp v27, v44, v7 row_newbcast:0 row_mask:0xf bank_mask:0xf
    s_waitcnt vmcnt(17)
    s_nop 0
    v_mfma_f32_16x16x32_bf16 v[20:23], v[24:27], v[100:103], v[20:23]
    buffer_load_dwordx4 v[100:103], v1, s[12:15], s85 offen offset:2048 nt
    v_and_b32_dpp v28, v44, v4 row_newbcast:8 row_mask:0xf bank_mask:0xf
    v_and_b32_dpp v29, v44, v5 row_newbcast:8 row_mask:0xf bank_mask:0xf
    v_and_b32_dpp v30, v44, v6 row_newbcast:8 row_mask:0xf bank_mask:0xf
    v_and_b32_dpp v31, v44, v7 row_newbcast:8 row_mask:0xf bank_mask:0xf
    s_waitcnt vmcnt(17)
    s_nop 0
    v_mfma_f32_16x16x32_bf16 v[20:23], v[28:31], v[104:107], v[20:23]
    buffer_load_dwordx4 v[104:107], v1, s[12:15], s85 offen offset:3072 nt
    v_and_b32_dpp v24, v44, v4 row_newbcast:4 row_mask:0xf bank_mask:0xf
    v_and_b32_dpp v25, v44, v5 row_newbcast:4 row_mask:0xf bank_mask:0xf
    v_and_b32_dpp v26, v44, v6 row_newbcast:4 row_mask:0xf bank_mask:0xf
    v_and_b32_dpp v27, v44, v7 row_newbcast:4 row_mask:0xf bank_mask:0xf
    s_waitcnt vmcnt(17)
    s_nop 0
    v_mfma_f32_16x16x32_bf16 v[20:23], v[24:27], v[108:111], v[20:23]
    s_add_u32 s85, s84, 0x81000
    buffer_load_dwordx4 v[108:111], v1, s[12:15], s85 offen offset:0 nt
    v_and_b32_dpp v28, v44, v4 row_newbcast:12 row_mask:0xf bank_mask:0xf
    v_and_b32_dpp v29, v44, v5 row_newbcast:12 row_mask:0xf bank_mask:0xf
    v_and_b32_dpp v30, v44, v6 row_newbcast:12 row_mask:0xf bank_mask:0xf
    v_and_b32_dpp v31, v44, v7 row_newbcast:12 row_mask:0xf bank_mask:0xf
    s_waitcnt vmcnt(17)
    s_nop 0
    v_mfma_f32_16x16x32_bf16 v[20:23], v[28:31], v[112:115], v[20:23]
    buffer_load_dwordx4 v[112:115], v1, s[12:15], s85 offen offset:1024 nt
    v_and_b32_dpp v24, v45, v4 row_newbcast:0 row_mask:0xf bank_mask:0xf
    v_and_b32_dpp v25, v45, v5 row_newbcast:0 row_mask:0xf bank_mask:0xf
    v_and_b32_dpp v26, v45, v6 row_newbcast:0 row_mask:0xf bank_mask:0xf
    v_and_b32_dpp v27, v45, v7 row_newbcast:0 row_mask:0xf bank_mask:0xf
    s_waitcnt vmcnt(17)
    s_nop 0
    v_mfma_f32_16x16x32_bf16 v[20:23], v[24:27], v[116:119], v[20:23]
    buffer_load_dwordx4 v[116:119], v1, s[12:15], s85 offen offset:2048 nt
    v_and_b32_dpp v28, v45, v4 row_newbcast:8 row_mask:0xf bank_mask:0xf
    v_and_b32_dpp v29, v45, v5 row_newbcast:8 row_mask:0xf bank_mask:0xf
    v_and_b32_dpp v30, v45, v6 row_newbcast:8 row_mask:0xf bank_mask:0xf
    v_and_b32_dpp v31, v45, v7 row_newbcast:8 row_mask:0xf bank_mask:0xf
    s_waitcnt vmcnt(17)
    s_nop 0
    v_mfma_f32_16x16x32_bf16 v[20:23], v[28:31], v[120:123], v[20:23]
    buffer_load_dwordx4 v[120:123], v1, s[12:15], s85 offen offset:3072 nt
    v_and_b32_dpp v24, v45, v4 row_newbcast:4 row_mask:0xf bank_mask:0xf
    v_and_b32_dpp v25, v45, v5 row_newbcast:4 row_mask:0xf bank_mask:0xf
    v_and_b32_dpp v26, v45, v6 row_newbcast:4 row_mask:0xf bank_mask:0xf
    v_and_b32_dpp v27, v45, v7 row_newbcast:4 row_mask:0xf bank_mask:0xf
    s_waitcnt vmcnt(17)
    s_nop 0
    v_mfma_f32_16x16x32_bf16 v[20:23], v[24:27], v[124:127], v[20:23]
    v_lshlrev_b32 v17, 4, v0
    buffer_load_dwordx4 v[124:127], v17, s[64:67], 0 offen offset:0
    v_and_b32_dpp v28, v45, v4 row_newbcast:12 row_mask:0xf bank_mask:0xf
    v_and_b32_dpp v29, v45, v5 row_newbcast:12 row_mask:0xf bank_mask:0xf
    v_and_b32_dpp v30, v45, v6 row_newbcast:12 row_mask:0xf bank_mask:0xf
    v_and_b32_dpp v31, v45, v7 row_newbcast:12 row_mask:0xf bank_mask:0xf
    s_waitcnt vmcnt(17)
    s_nop 0
    v_mfma_f32_16x16x32_bf16 v[20:23], v[28:31], v[56:59], v[20:23]
    buffer_load_dwordx4 v[56:59], v17, s[64:67], 0 offen offset:1024
    s_waitcnt vmcnt(17)
    v_dot2_f32_bf16 v32, v60, v8, 0
    v_dot2_f32_bf16 v32, v61, v9, v32
    v_dot2_f32_bf16 v32, v62, v10, v32
    v_dot2_f32_bf16 v32, v63, v11, v32
    buffer_load_dwordx4 v[60:63], v17, s[68:71], 0 offen offset:0
    s_waitcnt vmcnt(17)
    v_dot2_f32_bf16 v33, v64, v8, 0
    v_dot2_f32_bf16 v33, v65, v9, v33
    v_dot2_f32_bf16 v33, v66, v10, v33
    v_dot2_f32_bf16 v33, v67, v11, v33
    buffer_load_dwordx4 v[64:67], v17, s[68:71], 0 offen offset:1024
    s_waitcnt vmcnt(17)
    v_dot2_f32_bf16 v34, v68, v8, 0
    v_dot2_f32_bf16 v34, v69, v9, v34
    v_dot2_f32_bf16 v34, v70, v10, v34
    v_dot2_f32_bf16 v34, v71, v11, v34
    s_mul_i32 s7, s3, 36
    v_add_u32 v17, s7, v3
    v_mul_u32_u24 v17, 9216, v17
    v_and_b32 v55, 16, v2
    v_add3_u32 v55, v55, v17, 64
    v_add_u32 v55, 192, v55
    v_add_u32 v17, v17, v2
    buffer_load_dwordx4 v[68:71], v17, s[20:23], 0 offen
    s_waitcnt vmcnt(17)
    v_dot2_f32_bf16 v35, v72, v8, 0
    v_dot2_f32_bf16 v35, v73, v9, v35
    v_dot2_f32_bf16 v35, v74, v10, v35
    v_dot2_f32_bf16 v35, v75, v11, v35
    buffer_load_dwordx4 v[72:75], v17, s[24:27], 0 offen
    s_waitcnt vmcnt(17)
    v_dot2_f32_bf16 v36, v76, v8, 0
    v_dot2_f32_bf16 v36, v77, v9, v36
    v_dot2_f32_bf16 v36, v78, v10, v36
    v_dot2_f32_bf16 v36, v79, v11, v36
    s_mov_b32 exec_lo, 0x00030003
    s_mov_b32 exec_hi, 0x00030003
    buffer_load_dwordx4 v[76:79], v55, s[20:23], 0 offen
    s_mov_b32 exec_lo, 0x000c000c
    s_mov_b32 exec_hi, 0x000c000c
    buffer_load_dwordx4 v[76:79], v55, s[24:27], 0 offen
    s_mov_b64 exec, -1
    s_waitcnt vmcnt(18)
    v_dot2_f32_bf16 v37, v80, v8, 0
    v_dot2_f32_bf16 v37, v81, v9, v37
    v_dot2_f32_bf16 v37, v82, v10, v37
    v_dot2_f32_bf16 v37, v83, v11, v37
    s_mov_b32 s86, 0x9000
    buffer_load_dwordx4 v[80:83], v17, s[20:23], s86 offen
    s_waitcnt vmcnt(18)
    v_dot2_f32_bf16 v38, v84, v8, 0
    v_dot2_f32_bf16 v38, v85, v9, v38
    v_dot2_f32_bf16 v38, v86, v10, v38
    v_dot2_f32_bf16 v38, v87, v11, v38
    buffer_load_dwordx4 v[84:87], v17, s[24:27], s86 offen
    s_waitcnt vmcnt(18)
    v_dot2_f32_bf16 v39, v88, v8, 0
    v_dot2_f32_bf16 v39, v89, v9, v39
    v_dot2_f32_bf16 v39, v90, v10, v39
    v_dot2_f32_bf16 v39, v91, v11, v39
    s_mov_b32 exec_lo, 0x00030003
    s_mov_b32 exec_hi, 0x00030003
    buffer_load_dwordx4 v[88:91], v55, s[20:23], s86 offen
    s_mov_b32 exec_lo, 0x000c000c
    s_mov_b32 exec_hi, 0x000c000c
    buffer_load_dwordx4 v[88:91], v55, s[24:27], s86 offen
    s_mov_b64 exec, -1
    v_add_f32_dpp v40, v32, v32 row_ror:8 row_mask:0xf bank_mask:0x3
    v_add_f32_dpp v40, v33, v33 row_ror:8 row_mask:0xf bank_mask:0xc
    v_add_f32_dpp v41, v34, v34 row_ror:8 row_mask:0xf bank_mask:0x3
    v_add_f32_dpp v41, v35, v35 row_ror:8 row_mask:0xf bank_mask:0xc
    v_add_f32_dpp v42, v36, v36 row_ror:8 row_mask:0xf bank_mask:0x3
    v_add_f32_dpp v42, v37, v37 row_ror:8 row_mask:0xf bank_mask:0xc
    v_add_f32_dpp v43, v38, v38 row_ror:8 row_mask:0xf bank_mask:0x3
    v_add_f32_dpp v43, v39, v39 row_ror:8 row_mask:0xf bank_mask:0xc
    v_add_f32_dpp v44, v40, v40 row_half_mirror row_mask:0xf bank_mask:0x5
    v_add_f32_dpp v44, v41, v41 row_half_mirror row_mask:0xf bank_mask:0xa
    v_add_f32_dpp v45, v42, v42 row_half_mirror row_mask:0xf bank_mask:0x5
    v_add_f32_dpp v45, v43, v43 row_half_mirror row_mask:0xf bank_mask:0xa
    v_add_f32_dpp v44, v44, v44 quad_perm:[1,0,3,2] row_mask:0xf bank_mask:0xf
    s_nop 0
    v_add_f32_dpp v45, v45, v45 quad_perm:[1,0,3,2] row_mask:0xf bank_mask:0xf
    v_add_f32_dpp v44, v44, v44 quad_perm:[2,3,0,1] row_mask:0xf bank_mask:0xf
    s_nop 0
    v_add_f32_dpp v45, v45, v45 quad_perm:[2,3,0,1] row_mask:0xf bank_mask:0xf
    v_cvt_pk_bf16_f32 v40, v44, v45
    v_lshlrev_b32 v44, 16, v40
    v_and_b32 v45, s99, v40
    v_mul_f32 v44, s96, v44
    v_mul_f32 v45, s96, v45
    v_cvt_pk_bf16_f32 v40, v44, v45
    v_lshlrev_b32 v44, 16, v40
    v_and_b32 v45, s99, v40
    v_max_f32 v46, v44, v45
    s_nop 1
    v_max_f32_dpp v46, v46, v46 row_ror:4 row_mask:0xf bank_mask:0xf
    s_nop 1
    v_max_f32_dpp v46, v46, v46 row_ror:8 row_mask:0xf bank_mask:0xf
    s_nop 0
    v_readlane_b32 s88, v46, 0
    v_readlane_b32 s89, v46, 16
    v_readlane_b32 s90, v46, 32
    v_readlane_b32 s91, v46, 48
    v_max_f32 v46, s88, v13
    v_max_f32 v46, s89, v46
    v_max_f32 v46, s90, v46
    v_max_f32 v46, s91, v46
    v_sub_f32 v47, v13, v46
    v_sub_f32 v44, v44, v46
    v_sub_f32 v45, v45, v46
    v_mul_f32 v47, s97, v47
    v_mul_f32 v44, s97, v44
    v_mul_f32 v45, s97, v45
    v_exp_f32 v47, v47
    v_exp_f32 v44, v44
    v_exp_f32 v45, v45
    v_mov_b32 v13, v46
    v_fma_f32 v14, v14, v47, v44
    v_add_f32 v14, v14, v45
    v_mul_f32 v20, v20, v47
    v_mul_f32 v21, v21, v47
    v_mul_f32 v22, v22, v47
    v_mul_f32 v23, v23, v47
    v_cvt_pk_bf16_f32 v44, v44, v44
    v_cvt_pk_bf16_f32 v45, v45, v45
    s_nop 0
    v_and_b32_dpp v24, v44, v4 row_newbcast:0 row_mask:0xf bank_mask:0xf
    v_and_b32_dpp v25, v44, v5 row_newbcast:0 row_mask:0xf bank_mask:0xf
    v_and_b32_dpp v26, v44, v6 row_newbcast:0 row_mask:0xf bank_mask:0xf
    v_and_b32_dpp v27, v44, v7 row_newbcast:0 row_mask:0xf bank_mask:0xf
    s_waitcnt vmcnt(19)
    s_nop 0
    v_mfma_f32_16x16x32_bf16 v[20:23], v[24:27], v[92:95], v[20:23]
    s_mov_b32 s86, 0x12000
    buffer_load_dwordx4 v[92:95], v17, s[20:23], s86 offen
    v_and_b32_dpp v28, v44, v4 row_newbcast:8 row_mask:0xf bank_mask:0xf
    v_and_b32_dpp v29, v44, v5 row_newbcast:8 row_mask:0xf bank_mask:0xf
    v_and_b32_dpp v30, v44, v6 row_newbcast:8 row_mask:0xf bank_mask:0xf
    v_and_b32_dpp v31, v44, v7 row_newbcast:8 row_mask:0xf bank_mask:0xf
    s_waitcnt vmcnt(19)
    s_nop 0
    v_mfma_f32_16x16x32_bf16 v[20:23], v[28:31], v[96:99], v[20:23]
    buffer_load_dwordx4 v[96:99], v17, s[24:27], s86 offen
    v_and_b32_dpp v24, v44, v4 row_newbcast:4 row_mask:0xf bank_mask:0xf
    v_and_b32_dpp v25, v44, v5 row_newbcast:4 row_mask:0xf bank_mask:0xf
    v_and_b32_dpp v26, v44, v6 row_newbcast:4 row_mask:0xf bank_mask:0xf
    v_and_b32_dpp v27, v44, v7 row_newbcast:4 row_mask:0xf bank_mask:0xf
    s_waitcnt vmcnt(19)
    s_nop 0
    v_mfma_f32_16x16x32_bf16 v[20:23], v[24:27], v[100:103], v[20:23]
    s_mov_b32 exec_lo, 0x00030003
    s_mov_b32 exec_hi, 0x00030003
    buffer_load_dwordx4 v[100:103], v55, s[20:23], s86 offen
    s_mov_b32 exec_lo, 0x000c000c
    s_mov_b32 exec_hi, 0x000c000c
    buffer_load_dwordx4 v[100:103], v55, s[24:27], s86 offen
    s_mov_b64 exec, -1
    v_and_b32_dpp v28, v44, v4 row_newbcast:12 row_mask:0xf bank_mask:0xf
    v_and_b32_dpp v29, v44, v5 row_newbcast:12 row_mask:0xf bank_mask:0xf
    v_and_b32_dpp v30, v44, v6 row_newbcast:12 row_mask:0xf bank_mask:0xf
    v_and_b32_dpp v31, v44, v7 row_newbcast:12 row_mask:0xf bank_mask:0xf
    s_waitcnt vmcnt(20)
    s_nop 0
    v_mfma_f32_16x16x32_bf16 v[20:23], v[28:31], v[104:107], v[20:23]
    s_mov_b32 s86, 0x1b000
    buffer_load_dwordx4 v[104:107], v17, s[20:23], s86 offen
    v_and_b32_dpp v24, v45, v4 row_newbcast:0 row_mask:0xf bank_mask:0xf
    v_and_b32_dpp v25, v45, v5 row_newbcast:0 row_mask:0xf bank_mask:0xf
    v_and_b32_dpp v26, v45, v6 row_newbcast:0 row_mask:0xf bank_mask:0xf
    v_and_b32_dpp v27, v45, v7 row_newbcast:0 row_mask:0xf bank_mask:0xf
    s_waitcnt vmcnt(20)
    s_nop 0
    v_mfma_f32_16x16x32_bf16 v[20:23], v[24:27], v[108:111], v[20:23]
    buffer_load_dwordx4 v[108:111], v17, s[24:27], s86 offen
    v_and_b32_dpp v28, v45, v4 row_newbcast:8 row_mask:0xf bank_mask:0xf
    v_and_b32_dpp v29, v45, v5 row_newbcast:8 row_mask:0xf bank_mask:0xf
    v_and_b32_dpp v30, v45, v6 row_newbcast:8 row_mask:0xf bank_mask:0xf
    v_and_b32_dpp v31, v45, v7 row_newbcast:8 row_mask:0xf bank_mask:0xf
    s_waitcnt vmcnt(20)
    s_nop 0
    v_mfma_f32_16x16x32_bf16 v[20:23], v[28:31], v[112:115], v[20:23]
    s_mov_b32 exec_lo, 0x00030003
    s_mov_b32 exec_hi, 0x00030003
    buffer_load_dwordx4 v[112:115], v55, s[20:23], s86 offen
    s_mov_b32 exec_lo, 0x000c000c
    s_mov_b32 exec_hi, 0x000c000c
    buffer_load_dwordx4 v[112:115], v55, s[24:27], s86 offen
    s_mov_b64 exec, -1
    v_and_b32_dpp v24, v45, v4 row_newbcast:4 row_mask:0xf bank_mask:0xf
    v_and_b32_dpp v25, v45, v5 row_newbcast:4 row_mask:0xf bank_mask:0xf
    v_and_b32_dpp v26, v45, v6 row_newbcast:4 row_mask:0xf bank_mask:0xf
    v_and_b32_dpp v27, v45, v7 row_newbcast:4 row_mask:0xf bank_mask:0xf
    s_waitcnt vmcnt(21)
    s_nop 0
    v_mfma_f32_16x16x32_bf16 v[20:23], v[24:27], v[116:119], v[20:23]
    s_mov_b32 s86, 0x24000
    buffer_load_dwordx4 v[116:119], v17, s[20:23], s86 offen
    v_and_b32_dpp v28, v45, v4 row_newbcast:12 row_mask:0xf bank_mask:0xf
    v_and_b32_dpp v29, v45, v5 row_newbcast:12 row_mask:0xf bank_mask:0xf
    v_and_b32_dpp v30, v45, v6 row_newbcast:12 row_mask:0xf bank_mask:0xf
    v_and_b32_dpp v31, v45, v7 row_newbcast:12 row_mask:0xf bank_mask:0xf
    s_waitcnt vmcnt(21)
    s_nop 0
    v_mfma_f32_16x16x32_bf16 v[20:23], v[28:31], v[120:123], v[20:23]
    buffer_load_dwordx4 v[120:123], v17, s[24:27], s86 offen
    s_waitcnt vmcnt(21)
    s_waitcnt vmcnt(20)
    s_waitcnt vmcnt(19)
    s_waitcnt vmcnt(18)
    v_mov_b32 v32, 0
    v_lshlrev_b32 v33, 16, v124
    v_and_b32 v34, s99, v124
    v_lshlrev_b32 v35, 16, v60
    v_and_b32 v36, s99, v60
    v_mul_f32 v33, v33, v35
    v_mul_f32 v34, v34, v36
    v_cvt_pk_bf16_f32 v37, v33, v34
    v_lshlrev_b32 v33, 16, v37
    v_and_b32 v34, s99, v37
    v_add_f32 v32, v32, v33
    v_add_f32 v32, v32, v34
    v_lshlrev_b32 v33, 16, v125
    v_and_b32 v34, s99, v125
    v_lshlrev_b32 v35, 16, v61
    v_and_b32 v36, s99, v61
    v_mul_f32 v33, v33, v35
    v_mul_f32 v34, v34, v36
    v_cvt_pk_bf16_f32 v37, v33, v34
    v_lshlrev_b32 v33, 16, v37
    v_and_b32 v34, s99, v37
    v_add_f32 v32, v32, v33
    v_add_f32 v32, v32, v34
    v_lshlrev_b32 v33, 16, v126
    v_and_b32 v34, s99, v126
    v_lshlrev_b32 v35, 16, v62
    v_and_b32 v36, s99, v62
    v_mul_f32 v33, v33, v35
    v_mul_f32 v34, v34, v36
    v_cvt_pk_bf16_f32 v37, v33, v34
    v_lshlrev_b32 v33, 16, v37
    v_and_b32 v34, s99, v37
    v_add_f32 v32, v32, v33
    v_add_f32 v32, v32, v34
    v_lshlrev_b32 v33, 16, v127
    v_and_b32 v34, s99, v127
    v_lshlrev_b32 v35, 16, v63
    v_and_b32 v36, s99, v63
    v_mul_f32 v33, v33, v35
    v_mul_f32 v34, v34, v36
    v_cvt_pk_bf16_f32 v37, v33, v34
    v_lshlrev_b32 v33, 16, v37
    v_and_b32 v34, s99, v37
    v_add_f32 v32, v32, v33
    v_add_f32 v32, v32, v34
    v_lshlrev_b32 v33, 16, v56
    v_and_b32 v34, s99, v56
    v_lshlrev_b32 v35, 16, v64
    v_and_b32 v36, s99, v64
    v_mul_f32 v33, v33, v35
    v_mul_f32 v34, v34, v36
    v_cvt_pk_bf16_f32 v37, v33, v34
    v_lshlrev_b32 v33, 16, v37
    v_and_b32 v34, s99, v37
    v_add_f32 v32, v32, v33
    v_add_f32 v32, v32, v34
    v_lshlrev_b32 v33, 16, v57
    v_and_b32 v34, s99, v57
    v_lshlrev_b32 v35, 16, v65
    v_and_b32 v36, s99, v65
    v_mul_f32 v33, v33, v35
    v_mul_f32 v34, v34, v36
    v_cvt_pk_bf16_f32 v37, v33, v34
    v_lshlrev_b32 v33, 16, v37
    v_and_b32 v34, s99, v37
    v_add_f32 v32, v32, v33
    v_add_f32 v32, v32, v34
    v_lshlrev_b32 v33, 16, v58
    v_and_b32 v34, s99, v58
    v_lshlrev_b32 v35, 16, v66
    v_and_b32 v36, s99, v66
    v_mul_f32 v33, v33, v35
    v_mul_f32 v34, v34, v36
    v_cvt_pk_bf16_f32 v37, v33, v34
    v_lshlrev_b32 v33, 16, v37
    v_and_b32 v34, s99, v37
    v_add_f32 v32, v32, v33
    v_add_f32 v32, v32, v34
    v_lshlrev_b32 v33, 16, v59
    v_and_b32 v34, s99, v59
    v_lshlrev_b32 v35, 16, v67
    v_and_b32 v36, s99, v67
    v_mul_f32 v33, v33, v35
    v_mul_f32 v34, v34, v36
    v_cvt_pk_bf16_f32 v37, v33, v34
    v_lshlrev_b32 v33, 16, v37
    v_and_b32 v34, s99, v37
    v_add_f32 v32, v32, v33
    v_add_f32 v32, v32, v34
    s_nop 1
    v_add_f32_dpp v32, v32, v32 row_ror:1 row_mask:0xf bank_mask:0xf
    s_nop 1
    v_add_f32_dpp v32, v32, v32 row_ror:2 row_mask:0xf bank_mask:0xf
    s_nop 1
    v_add_f32_dpp v32, v32, v32 row_ror:4 row_mask:0xf bank_mask:0xf
    s_nop 1
    v_add_f32_dpp v32, v32, v32 row_ror:8 row_mask:0xf bank_mask:0xf
    s_nop 0
    v_readlane_b32 s88, v32, 0
    v_readlane_b32 s89, v32, 16
    v_readlane_b32 s90, v32, 32
    v_readlane_b32 s91, v32, 48
    v_mov_b32 v32, s88
    v_add_f32 v32, s89, v32
    v_add_f32 v32, s90, v32
    v_add_f32 v32, s91, v32
    v_cvt_pk_bf16_f32 v32, v32, v32
    v_lshlrev_b32 v32, 16, v32
    v_mul_f32 v32, s97, v32
    v_sub_f32 v32, 0, v32
    v_exp_f32 v32, v32
    s_nop 0
    v_add_f32 v32, 1.0, v32
    v_rcp_f32 v15, v32
    s_nop 0
    v_cvt_pk_bf16_f32 v15, v15, v15
    v_lshlrev_b32 v15, 16, v15
    v_sub_f32 v16, 1.0, v15
    v_cvt_pk_bf16_f32 v16, v16, v16
    v_lshlrev_b32 v16, 16, v16
    s_mov_b32 exec_lo, 0x00030003
    s_mov_b32 exec_hi, 0x00030003
    buffer_load_dwordx4 v[124:127], v55, s[20:23], s86 offen
    s_mov_b32 exec_lo, 0x000c000c
    s_mov_b32 exec_hi, 0x000c000c
    buffer_load_dwordx4 v[124:127], v55, s[24:27], s86 offen
    s_mov_b64 exec, -1
    s_mov_b32 s86, 0x2d000
    buffer_load_dwordx4 v[56:59], v17, s[20:23], s86 offen
    buffer_load_dwordx4 v[60:63], v17, s[24:27], s86 offen
    s_mov_b32 exec_lo, 0x00030003
    s_mov_b32 exec_hi, 0x00030003
    buffer_load_dwordx4 v[64:67], v55, s[20:23], s86 offen
    s_mov_b32 exec_lo, 0x000c000c
    s_mov_b32 exec_hi, 0x000c000c
    buffer_load_dwordx4 v[64:67], v55, s[24:27], s86 offen
    s_mov_b64 exec, -1
    v_and_b32_dpp v24, v12, v4 row_newbcast:0 row_mask:0xf bank_mask:0xf
    v_and_b32_dpp v25, v12, v5 row_newbcast:0 row_mask:0xf bank_mask:0xf
    v_and_b32_dpp v26, v12, v6 row_newbcast:0 row_mask:0xf bank_mask:0xf
    v_and_b32_dpp v27, v12, v7 row_newbcast:0 row_mask:0xf bank_mask:0xf
    s_waitcnt vmcnt(23)
    s_nop 0
    v_mfma_f32_16x16x32_bf16 v[32:35], v[24:27], v[68:71], 0
    s_mov_b32 s86, 0x36000
    buffer_load_dwordx4 v[68:71], v17, s[20:23], s86 offen
    s_waitcnt vmcnt(23)
    v_mfma_f32_16x16x32_bf16 v[36:39], v[24:27], v[72:75], 0
    buffer_load_dwordx4 v[72:75], v17, s[24:27], s86 offen
    s_waitcnt vmcnt(22)
    v_mfma_f32_16x16x32_bf16 v[40:43], v[24:27], v[76:79], 0
    s_mov_b32 exec_lo, 0x00030003
    s_mov_b32 exec_hi, 0x00030003
    buffer_load_dwordx4 v[76:79], v55, s[20:23], s86 offen
    s_mov_b32 exec_lo, 0x000c000c
    s_mov_b32 exec_hi, 0x000c000c
    buffer_load_dwordx4 v[76:79], v55, s[24:27], s86 offen
    s_mov_b64 exec, -1
    v_and_b32_dpp v28, v12, v4 row_newbcast:1 row_mask:0xf bank_mask:0xf
    v_and_b32_dpp v29, v12, v5 row_newbcast:1 row_mask:0xf bank_mask:0xf
    v_and_b32_dpp v30, v12, v6 row_newbcast:1 row_mask:0xf bank_mask:0xf
    v_and_b32_dpp v31, v12, v7 row_newbcast:1 row_mask:0xf bank_mask:0xf
    s_waitcnt vmcnt(23)
    s_nop 0
    v_mfma_f32_16x16x32_bf16 v[32:35], v[28:31], v[80:83], v[32:35]
    s_mov_b32 s86, 0x3f000
    buffer_load_dwordx4 v[80:83], v17, s[20:23], s86 offen
    s_waitcnt vmcnt(23)
    v_mfma_f32_16x16x32_bf16 v[36:39], v[28:31], v[84:87], v[36:39]
    buffer_load_dwordx4 v[84:87], v17, s[24:27], s86 offen
    s_waitcnt vmcnt(22)
    v_mfma_f32_16x16x32_bf16 v[40:43], v[28:31], v[88:91], v[40:43]
    s_mov_b32 exec_lo, 0x00030003
    s_mov_b32 exec_hi, 0x00030003
    buffer_load_dwordx4 v[88:91], v55, s[20:23], s86 offen
    s_mov_b32 exec_lo, 0x000c000c
    s_mov_b32 exec_hi, 0x000c000c
    buffer_load_dwordx4 v[88:91], v55, s[24:27], s86 offen
    s_mov_b64 exec, -1
    v_and_b32_dpp v24, v12, v4 row_newbcast:2 row_mask:0xf bank_mask:0xf
    v_and_b32_dpp v25, v12, v5 row_newbcast:2 row_mask:0xf bank_mask:0xf
    v_and_b32_dpp v26, v12, v6 row_newbcast:2 row_mask:0xf bank_mask:0xf
    v_and_b32_dpp v27, v12, v7 row_newbcast:2 row_mask:0xf bank_mask:0xf
    s_waitcnt vmcnt(23)
    s_nop 0
    v_mfma_f32_16x16x32_bf16 v[32:35], v[24:27], v[92:95], v[32:35]
    s_mov_b32 s86, 0x48000
    buffer_load_dwordx4 v[92:95], v17, s[20:23], s86 offen
    s_waitcnt vmcnt(23)
    v_mfma_f32_16x16x32_bf16 v[36:39], v[24:27], v[96:99], v[36:39]
    buffer_load_dwordx4 v[96:99], v17, s[24:27], s86 offen
    s_waitcnt vmcnt(22)
    v_mfma_f32_16x16x32_bf16 v[40:43], v[24:27], v[100:103], v[40:43]
    s_mov_b32 exec_lo, 0x00030003
    s_mov_b32 exec_hi, 0x00030003
    buffer_load_dwordx4 v[100:103], v55, s[20:23], s86 offen
    s_mov_b32 exec_lo, 0x000c000c
    s_mov_b32 exec_hi, 0x000c000c
    buffer_load_dwordx4 v[100:103], v55, s[24:27], s86 offen
    s_mov_b64 exec, -1
    v_and_b32_dpp v28, v12, v4 row_newbcast:3 row_mask:0xf bank_mask:0xf
    v_and_b32_dpp v29, v12, v5 row_newbcast:3 row_mask:0xf bank_mask:0xf
    v_and_b32_dpp v30, v12, v6 row_newbcast:3 row_mask:0xf bank_mask:0xf
    v_and_b32_dpp v31, v12, v7 row_newbcast:3 row_mask:0xf bank_mask:0xf
    s_waitcnt vmcnt(23)
    s_nop 0
    v_mfma_f32_16x16x32_bf16 v[32:35], v[28:31], v[104:107], v[32:35]
    s_add_u32 s85, s84, 0xa0000
    buffer_load_dwordx4 v[104:107], v1, s[8:11], s85 offen offset:0 nt
    s_waitcnt vmcnt(23)
    v_mfma_f32_16x16x32_bf16 v[36:39], v[28:31], v[108:111], v[36:39]
    buffer_load_dwordx4 v[108:111], v1, s[8:11], s85 offen offset:1024 nt
    s_waitcnt vmcnt(22)
    v_mfma_f32_16x16x32_bf16 v[40:43], v[28:31], v[112:115], v[40:43]
    buffer_load_dwordx4 v[112:115], v1, s[8:11], s85 offen offset:2048 nt
    v_and_b32_dpp v24, v12, v4 row_newbcast:4 row_mask:0xf bank_mask:0xf
    v_and_b32_dpp v25, v12, v5 row_newbcast:4 row_mask:0xf bank_mask:0xf
    v_and_b32_dpp v26, v12, v6 row_newbcast:4 row_mask:0xf bank_mask:0xf
    v_and_b32_dpp v27, v12, v7 row_newbcast:4 row_mask:0xf bank_mask:0xf
    s_waitcnt vmcnt(22)
    s_nop 0
    v_mfma_f32_16x16x32_bf16 v[32:35], v[24:27], v[116:119], v[32:35]
    buffer_load_dwordx4 v[116:119], v1, s[8:11], s85 offen offset:3072 nt
    s_waitcnt vmcnt(22)
    v_mfma_f32_16x16x32_bf16 v[36:39], v[24:27], v[120:123], v[36:39]
    s_add_u32 s85, s84, 0xa1000
    buffer_load_dwordx4 v[120:123], v1, s[8:11], s85 offen offset:0 nt
    s_waitcnt vmcnt(21)
    v_mfma_f32_16x16x32_bf16 v[40:43], v[24:27], v[124:127], v[40:43]
    buffer_load_dwordx4 v[124:127], v1, s[8:11], s85 offen offset:1024 nt
    v_and_b32_dpp v28, v12, v4 row_newbcast:5 row_mask:0xf bank_mask:0xf
    v_and_b32_dpp v29, v12, v5 row_newbcast:5 row_mask:0xf bank_mask:0xf
    v_and_b32_dpp v30, v12, v6 row_newbcast:5 row_mask:0xf bank_mask:0xf
    v_and_b32_dpp v31, v12, v7 row_newbcast:5 row_mask:0xf bank_mask:0xf
    s_waitcnt vmcnt(21)
    s_nop 0
    v_mfma_f32_16x16x32_bf16 v[32:35], v[28:31], v[56:59], v[32:35]
    buffer_load_dwordx4 v[56:59], v1, s[8:11], s85 offen offset:2048 nt
    s_waitcnt vmcnt(21)
    v_mfma_f32_16x16x32_bf16 v[36:39], v[28:31], v[60:63], v[36:39]
    buffer_load_dwordx4 v[60:63], v1, s[8:11], s85 offen offset:3072 nt
    s_waitcnt vmcnt(20)
    v_mfma_f32_16x16x32_bf16 v[40:43], v[28:31], v[64:67], v[40:43]
    s_add_u32 s85, s84, 0xa0000
    buffer_load_dwordx4 v[64:67], v1, s[12:15], s85 offen offset:0 nt
    v_and_b32_dpp v24, v12, v4 row_newbcast:6 row_mask:0xf bank_mask:0xf
    v_and_b32_dpp v25, v12, v5 row_newbcast:6 row_mask:0xf bank_mask:0xf
    v_and_b32_dpp v26, v12, v6 row_newbcast:6 row_mask:0xf bank_mask:0xf
    v_and_b32_dpp v27, v12, v7 row_newbcast:6 row_mask:0xf bank_mask:0xf
    s_waitcnt vmcnt(20)
    s_nop 0
    v_mfma_f32_16x16x32_bf16 v[32:35], v[24:27], v[68:71], v[32:35]
    buffer_load_dwordx4 v[68:71], v1, s[12:15], s85 offen offset:1024 nt
    s_waitcnt vmcnt(20)
    v_mfma_f32_16x16x32_bf16 v[36:39], v[24:27], v[72:75], v[36:39]
    buffer_load_dwordx4 v[72:75], v1, s[12:15], s85 offen offset:2048 nt
    s_waitcnt vmcnt(19)
    v_mfma_f32_16x16x32_bf16 v[40:43], v[24:27], v[76:79], v[40:43]
    buffer_load_dwordx4 v[76:79], v1, s[12:15], s85 offen offset:3072 nt
    v_and_b32_dpp v28, v12, v4 row_newbcast:7 row_mask:0xf bank_mask:0xf
    v_and_b32_dpp v29, v12, v5 row_newbcast:7 row_mask:0xf bank_mask:0xf
    v_and_b32_dpp v30, v12, v6 row_newbcast:7 row_mask:0xf bank_mask:0xf
    v_and_b32_dpp v31, v12, v7 row_newbcast:7 row_mask:0xf bank_mask:0xf
    s_waitcnt vmcnt(19)
    s_nop 0
    v_mfma_f32_16x16x32_bf16 v[32:35], v[28:31], v[80:83], v[32:35]
    s_add_u32 s85, s84, 0xa1000
    buffer_load_dwordx4 v[80:83], v1, s[12:15], s85 offen offset:0 nt
    s_waitcnt vmcnt(19)
    v_mfma_f32_16x16x32_bf16 v[36:39], v[28:31], v[84:87], v[36:39]
    buffer_load_dwordx4 v[84:87], v1, s[12:15], s85 offen offset:1024 nt
    s_waitcnt vmcnt(18)
    v_mfma_f32_16x16x32_bf16 v[40:43], v[28:31], v[88:91], v[40:43]
    buffer_load_dwordx4 v[88:91], v1, s[12:15], s85 offen offset:2048 nt
    v_and_b32_dpp v24, v12, v4 row_newbcast:8 row_mask:0xf bank_mask:0xf
    v_and_b32_dpp v25, v12, v5 row_newbcast:8 row_mask:0xf bank_mask:0xf
    v_and_b32_dpp v26, v12, v6 row_newbcast:8 row_mask:0xf bank_mask:0xf
    v_and_b32_dpp v27, v12, v7 row_newbcast:8 row_mask:0xf bank_mask:0xf
    s_waitcnt vmcnt(18)
    s_nop 0
    v_mfma_f32_16x16x32_bf16 v[32:35], v[24:27], v[92:95], v[32:35]
    buffer_load_dwordx4 v[92:95], v1, s[12:15], s85 offen offset:3072 nt
    s_waitcnt vmcnt(18)
    v_mfma_f32_16x16x32_bf16 v[36:39], v[24:27], v[96:99], v[36:39]
    s_add_u32 s85, s84, 0xc0000
    buffer_load_dwordx4 v[96:99], v1, s[8:11], s85 offen offset:0 nt
    s_waitcnt vmcnt(17)
    v_mfma_f32_16x16x32_bf16 v[40:43], v[24:27], v[100:103], v[40:43]
    buffer_load_dwordx4 v[100:103], v1, s[8:11], s85 offen offset:1024 nt
    s_mul_i32 s6, s3, 1536
    v_add_u32 v19, s6, v18
    s_mov_b32 exec_lo, -1
    s_mov_b32 exec_hi, 0
    ds_write_b128 v19, v[32:35] offset:17792
    ds_write_b128 v19, v[36:39] offset:18304
    s_nop 0
    ds_write_b128 v19, v[40:43] offset:18816
    s_mov_b64 exec, -1
    s_waitcnt lgkmcnt(0)
    s_barrier
    s_cmp_ge_u32 s3, 3
    s_cbranch_scc1 L_hred_2
    s_lshl_b32 s6, s3, 6
    v_add_u32 v19, s6, v0
    s_cmp_eq_u32 s3, 2
    s_cselect_b32 s6, 512, 0
    s_cselect_b32 s7, 64, 0
    s_add_u32 s7, s7, 512
    v_lshlrev_b32 v48, 2, v19
    v_add_u32 v49, s7, v48
    v_add_u32 v48, s6, v48
    ds_read_b32 v32, v48 offset:17792
    ds_read_b32 v33, v48 offset:19328
    ds_read_b32 v34, v48 offset:20864
    ds_read_b32 v35, v48 offset:22400
    ds_read_b32 v36, v48 offset:23936
    ds_read_b32 v37, v48 offset:25472
    ds_read_b32 v38, v48 offset:27008
    ds_read_b32 v39, v48 offset:28544
    ds_read_b32 v40, v48 offset:30080
    ds_read_b32 v41, v48 offset:31616
    ds_read_b32 v42, v48 offset:33152
    ds_read_b32 v43, v48 offset:34688
    ds_read_b32 v44, v48 offset:36224
    ds_read_b32 v45, v48 offset:37760
    ds_read_b32 v46, v48 offset:39296
    ds_read_b32 v47, v48 offset:40832
    s_waitcnt lgkmcnt(0)
    v_add_f32 v32, v32, v40
    v_add_f32 v33, v33, v41
    v_add_f32 v34, v34, v42
    v_add_f32 v35, v35, v43
    v_add_f32 v36, v36, v44
    v_add_f32 v37, v37, v45
    v_add_f32 v38, v38, v46
    v_add_f32 v39, v39, v47
    v_add_f32 v32, v32, v36
    v_add_f32 v33, v33, v37
    v_add_f32 v34, v34, v38
    v_add_f32 v35, v35, v39
    v_add_f32 v32, v32, v34
    v_add_f32 v33, v33, v35
    v_add_f32 v50, v32, v33
    ds_read_b32 v32, v49 offset:17792
    ds_read_b32 v33, v49 offset:19328
    ds_read_b32 v34, v49 offset:20864
    ds_read_b32 v35, v49 offset:22400
    ds_read_b32 v36, v49 offset:23936
    ds_read_b32 v37, v49 offset:25472
    ds_read_b32 v38, v49 offset:27008
    ds_read_b32 v39, v49 offset:28544
    ds_read_b32 v40, v49 offset:30080
    ds_read_b32 v41, v49 offset:31616
    ds_read_b32 v42, v49 offset:33152
    ds_read_b32 v43, v49 offset:34688
    ds_read_b32 v44, v49 offset:36224
    ds_read_b32 v45, v49 offset:37760
    ds_read_b32 v46, v49 offset:39296
    ds_read_b32 v47, v49 offset:40832
    s_waitcnt lgkmcnt(0)
    v_add_f32 v32, v32, v40
    v_add_f32 v33, v33, v41
    v_add_f32 v34, v34, v42
    v_add_f32 v35, v35, v43
    v_add_f32 v36, v36, v44
    v_add_f32 v37, v37, v45
    v_add_f32 v38, v38, v46
    v_add_f32 v39, v39, v47
    v_add_f32 v32, v32, v36
    v_add_f32 v33, v33, v37
    v_add_f32 v34, v34, v38
    v_add_f32 v35, v35, v39
    v_add_f32 v32, v32, v34
    v_add_f32 v33, v33, v35
    v_add_f32 v51, v32, v33
    v_cvt_pk_bf16_f32 v32, v50, v51
    v_lshlrev_b32 v50, 16, v32
    v_and_b32 v51, s99, v32
    v_mul_f32 v32, v50, v50
    s_mov_b32 s6, 0x3d122279
    v_mov_b32 v33, 0x3f4c422a
    v_fma_f32 v32, v32, s6, v33
    v_mul_f32 v32, v32, v50
    v_mul_f32 v32, 0xc038aa3b, v32
    v_exp_f32 v32, v32
    s_nop 0
    v_add_f32 v32, 1.0, v32
    v_rcp_f32 v32, v32
    s_nop 0
    v_mul_f32 v32, v32, v50
    v_cvt_pk_bf16_f32 v32, v32, v32
    v_lshlrev_b32 v32, 16, v32
    v_mul_f32 v32, v32, v51
    v_cvt_pk_bf16_f32 v32, v32, v32
    v_cmp_gt_u32 vcc, 144, v19
    s_nop 1
    v_cndmask_b32 v32, 0, v32, vcc
    v_lshlrev_b32 v19, 1, v19
    ds_write_b16 v19, v32 offset:8704
L_hred_2:
    s_waitcnt vmcnt(17)
    v_dot2_f32_bf16 v32, v104, v8, 0
    v_dot2_f32_bf16 v32, v105, v9, v32
    v_dot2_f32_bf16 v32, v106, v10, v32
    v_dot2_f32_bf16 v32, v107, v11, v32
    buffer_load_dwordx4 v[104:107], v1, s[8:11], s85 offen offset:2048 nt
    s_waitcnt vmcnt(17)
    v_dot2_f32_bf16 v33, v108, v8, 0
    v_dot2_f32_bf16 v33, v109, v9, v33
    v_dot2_f32_bf16 v33, v110, v10, v33
    v_dot2_f32_bf16 v33, v111, v11, v33
    buffer_load_dwordx4 v[108:111], v1, s[8:11], s85 offen offset:3072 nt
    s_waitcnt vmcnt(17)
    v_dot2_f32_bf16 v34, v112, v8, 0
    v_dot2_f32_bf16 v34, v113, v9, v34
    v_dot2_f32_bf16 v34, v114, v10, v34
    v_dot2_f32_bf16 v34, v115, v11, v34
    s_add_u32 s85, s84, 0xc1000
    buffer_load_dwordx4 v[112:115], v1, s[8:11], s85 offen offset:0 nt
    s_waitcnt vmcnt(17)
    v_dot2_f32_bf16 v35, v116, v8, 0
    v_dot2_f32_bf16 v35, v117, v9, v35
    v_dot2_f32_bf16 v35, v118, v10, v35
    v_dot2_f32_bf16 v35, v119, v11, v35
    buffer_load_dwordx4 v[116:119], v1, s[8:11], s85 offen offset:1024 nt
    s_waitcnt vmcnt(17)
    v_dot2_f32_bf16 v36, v120, v8, 0
    v_dot2_f32_bf16 v36, v121, v9, v36
    v_dot2_f32_bf16 v36, v122, v10, v36
    v_dot2_f32_bf16 v36, v123, v11, v36
    buffer_load_dwordx4 v[120:123], v1, s[8:11], s85 offen offset:2048 nt
    s_waitcnt vmcnt(17)
    v_dot2_f32_bf16 v37, v124, v8, 0
    v_dot2_f32_bf16 v37, v125, v9, v37
    v_dot2_f32_bf16 v37, v126, v10, v37
    v_dot2_f32_bf16 v37, v127, v11, v37
    buffer_load_dwordx4 v[124:127], v1, s[8:11], s85 offen offset:3072 nt
    s_waitcnt vmcnt(17)
    v_dot2_f32_bf16 v38, v56, v8, 0
    v_dot2_f32_bf16 v38, v57, v9, v38
    v_dot2_f32_bf16 v38, v58, v10, v38
    v_dot2_f32_bf16 v38, v59, v11, v38
    s_add_u32 s85, s84, 0xc0000
    buffer_load_dwordx4 v[56:59], v1, s[12:15], s85 offen offset:0 nt
    s_waitcnt vmcnt(17)
    v_dot2_f32_bf16 v39, v60, v8, 0
    v_dot2_f32_bf16 v39, v61, v9, v39
    v_dot2_f32_bf16 v39, v62, v10, v39
    v_dot2_f32_bf16 v39, v63, v11, v39
    buffer_load_dwordx4 v[60:63], v1, s[12:15], s85 offen offset:1024 nt
    v_add_f32_dpp v40, v32, v32 row_ror:8 row_mask:0xf bank_mask:0x3
    v_add_f32_dpp v40, v33, v33 row_ror:8 row_mask:0xf bank_mask:0xc
    v_add_f32_dpp v41, v34, v34 row_ror:8 row_mask:0xf bank_mask:0x3
    v_add_f32_dpp v41, v35, v35 row_ror:8 row_mask:0xf bank_mask:0xc
    v_add_f32_dpp v42, v36, v36 row_ror:8 row_mask:0xf bank_mask:0x3
    v_add_f32_dpp v42, v37, v37 row_ror:8 row_mask:0xf bank_mask:0xc
    v_add_f32_dpp v43, v38, v38 row_ror:8 row_mask:0xf bank_mask:0x3
    v_add_f32_dpp v43, v39, v39 row_ror:8 row_mask:0xf bank_mask:0xc
    v_add_f32_dpp v44, v40, v40 row_half_mirror row_mask:0xf bank_mask:0x5
    v_add_f32_dpp v44, v41, v41 row_half_mirror row_mask:0xf bank_mask:0xa
    v_add_f32_dpp v45, v42, v42 row_half_mirror row_mask:0xf bank_mask:0x5
    v_add_f32_dpp v45, v43, v43 row_half_mirror row_mask:0xf bank_mask:0xa
    v_add_f32_dpp v44, v44, v44 quad_perm:[1,0,3,2] row_mask:0xf bank_mask:0xf
    s_nop 0
    v_add_f32_dpp v45, v45, v45 quad_perm:[1,0,3,2] row_mask:0xf bank_mask:0xf
    v_add_f32_dpp v44, v44, v44 quad_perm:[2,3,0,1] row_mask:0xf bank_mask:0xf
    s_nop 0
    v_add_f32_dpp v45, v45, v45 quad_perm:[2,3,0,1] row_mask:0xf bank_mask:0xf
    v_cvt_pk_bf16_f32 v40, v44, v45
    v_lshlrev_b32 v44, 16, v40
    v_and_b32 v45, s99, v40
    v_mul_f32 v44, s96, v44
    v_mul_f32 v45, s96, v45
    v_cvt_pk_bf16_f32 v40, v44, v45
    v_lshlrev_b32 v44, 16, v40
    v_and_b32 v45, s99, v40
    v_max_f32 v46, v44, v45
    s_nop 1
    v_max_f32_dpp v46, v46, v46 row_ror:4 row_mask:0xf bank_mask:0xf
    s_nop 1
    v_max_f32_dpp v46, v46, v46 row_ror:8 row_mask:0xf bank_mask:0xf
    s_nop 0
    v_readlane_b32 s88, v46, 0
    v_readlane_b32 s89, v46, 16
    v_readlane_b32 s90, v46, 32
    v_readlane_b32 s91, v46, 48
    v_max_f32 v46, s88, v13
    v_max_f32 v46, s89, v46
    v_max_f32 v46, s90, v46
    v_max_f32 v46, s91, v46
    v_sub_f32 v47, v13, v46
    v_sub_f32 v44, v44, v46
    v_sub_f32 v45, v45, v46
    v_mul_f32 v47, s97, v47
    v_mul_f32 v44, s97, v44
    v_mul_f32 v45, s97, v45
    v_exp_f32 v47, v47
    v_exp_f32 v44, v44
    v_exp_f32 v45, v45
    v_mov_b32 v13, v46
    v_fma_f32 v14, v14, v47, v44
    v_add_f32 v14, v14, v45
    v_mul_f32 v20, v20, v47
    v_mul_f32 v21, v21, v47
    v_mul_f32 v22, v22, v47
    v_mul_f32 v23, v23, v47
    v_cvt_pk_bf16_f32 v44, v44, v44
    v_cvt_pk_bf16_f32 v45, v45, v45
    s_nop 0
    v_and_b32_dpp v24, v44, v4 row_newbcast:0 row_mask:0xf bank_mask:0xf
    v_and_b32_dpp v25, v44, v5 row_newbcast:0 row_mask:0xf bank_mask:0xf
    v_and_b32_dpp v26, v44, v6 row_newbcast:0 row_mask:0xf bank_mask:0xf
    v_and_b32_dpp v27, v44, v7 row_newbcast:0 row_mask:0xf bank_mask:0xf
    s_waitcnt vmcnt(17)
    s_nop 0
    v_mfma_f32_16x16x32_bf16 v[20:23], v[24:27], v[64:67], v[20:23]
    buffer_load_dwordx4 v[64:67], v1, s[12:15], s85 offen offset:2048 nt
    v_and_b32_dpp v28, v44, v4 row_newbcast:8 row_mask:0xf bank_mask:0xf
    v_and_b32_dpp v29, v44, v5 row_newbcast:8 row_mask:0xf bank_mask:0xf
    v_and_b32_dpp v30, v44, v6 row_newbcast:8 row_mask:0xf bank_mask:0xf
    v_and_b32_dpp v31, v44, v7 row_newbcast:8 row_mask:0xf bank_mask:0xf
    s_waitcnt vmcnt(17)
    s_nop 0
    v_mfma_f32_16x16x32_bf16 v[20:23], v[28:31], v[68:71], v[20:23]
    buffer_load_dwordx4 v[68:71], v1, s[12:15], s85 offen offset:3072 nt
    v_and_b32_dpp v24, v44, v4 row_newbcast:4 row_mask:0xf bank_mask:0xf
    v_and_b32_dpp v25, v44, v5 row_newbcast:4 row_mask:0xf bank_mask:0xf
    v_and_b32_dpp v26, v44, v6 row_newbcast:4 row_mask:0xf bank_mask:0xf
    v_and_b32_dpp v27, v44, v7 row_newbcast:4 row_mask:0xf bank_mask:0xf
    s_waitcnt vmcnt(17)
    s_nop 0
    v_mfma_f32_16x16x32_bf16 v[20:23], v[24:27], v[72:75], v[20:23]
    s_add_u32 s85, s84, 0xc1000
    buffer_load_dwordx4 v[72:75], v1, s[12:15], s85 offen offset:0 nt
    v_and_b32_dpp v28, v44, v4 row_newbcast:12 row_mask:0xf bank_mask:0xf
    v_and_b32_dpp v29, v44, v5 row_newbcast:12 row_mask:0xf bank_mask:0xf
    v_and_b32_dpp v30, v44, v6 row_newbcast:12 row_mask:0xf bank_mask:0xf
    v_and_b32_dpp v31, v44, v7 row_newbcast:12 row_mask:0xf bank_mask:0xf
    s_waitcnt vmcnt(17)
    s_nop 0
    v_mfma_f32_16x16x32_bf16 v[20:23], v[28:31], v[76:79], v[20:23]
    buffer_load_dwordx4 v[76:79], v1, s[12:15], s85 offen offset:1024 nt
    v_and_b32_dpp v24, v45, v4 row_newbcast:0 row_mask:0xf bank_mask:0xf
    v_and_b32_dpp v25, v45, v5 row_newbcast:0 row_mask:0xf bank_mask:0xf
    v_and_b32_dpp v26, v45, v6 row_newbcast:0 row_mask:0xf bank_mask:0xf
    v_and_b32_dpp v27, v45, v7 row_newbcast:0 row_mask:0xf bank_mask:0xf
    s_waitcnt vmcnt(17)
    s_nop 0
    v_mfma_f32_16x16x32_bf16 v[20:23], v[24:27], v[80:83], v[20:23]
    buffer_load_dwordx4 v[80:83], v1, s[12:15], s85 offen offset:2048 nt
    v_and_b32_dpp v28, v45, v4 row_newbcast:8 row_mask:0xf bank_mask:0xf
    v_and_b32_dpp v29, v45, v5 row_newbcast:8 row_mask:0xf bank_mask:0xf
    v_and_b32_dpp v30, v45, v6 row_newbcast:8 row_mask:0xf bank_mask:0xf
    v_and_b32_dpp v31, v45, v7 row_newbcast:8 row_mask:0xf bank_mask:0xf
    s_waitcnt vmcnt(17)
    s_nop 0
    v_mfma_f32_16x16x32_bf16 v[20:23], v[28:31], v[84:87], v[20:23]
    buffer_load_dwordx4 v[84:87], v1, s[12:15], s85 offen offset:3072 nt
    v_and_b32_dpp v24, v45, v4 row_newbcast:4 row_mask:0xf bank_mask:0xf
    v_and_b32_dpp v25, v45, v5 row_newbcast:4 row_mask:0xf bank_mask:0xf
    v_and_b32_dpp v26, v45, v6 row_newbcast:4 row_mask:0xf bank_mask:0xf
    v_and_b32_dpp v27, v45, v7 row_newbcast:4 row_mask:0xf bank_mask:0xf
    s_waitcnt vmcnt(17)
    s_nop 0
    v_mfma_f32_16x16x32_bf16 v[20:23], v[24:27], v[88:91], v[20:23]
    s_lshl_b32 s7, s3, 2
    v_add_u32 v17, s7, v3
    v_mul_u32_u24 v17, 1152, v17
    v_add_u32 v17, v17, v2
    buffer_load_dwordx4 v[88:91], v17, s[28:31], 0 offen offset:0
    v_and_b32_dpp v28, v45, v4 row_newbcast:12 row_mask:0xf bank_mask:0xf
    v_and_b32_dpp v29, v45, v5 row_newbcast:12 row_mask:0xf bank_mask:0xf
    v_and_b32_dpp v30, v45, v6 row_newbcast:12 row_mask:0xf bank_mask:0xf
    v_and_b32_dpp v31, v45, v7 row_newbcast:12 row_mask:0xf bank_mask:0xf
    s_waitcnt vmcnt(17)
    s_nop 0
    v_mfma_f32_16x16x32_bf16 v[20:23], v[28:31], v[92:95], v[20:23]
    buffer_load_dwordx4 v[92:95], v17, s[28:31], 0 offen offset:256
    s_waitcnt vmcnt(17)
    v_dot2_f32_bf16 v32, v96, v8, 0
    v_dot2_f32_bf16 v32, v97, v9, v32
    v_dot2_f32_bf16 v32, v98, v10, v32
    v_dot2_f32_bf16 v32, v99, v11, v32
    buffer_load_dwordx4 v[96:99], v17, s[28:31], 0 offen offset:512
    s_waitcnt vmcnt(17)
    v_dot2_f32_bf16 v33, v100, v8, 0
    v_dot2_f32_bf16 v33, v101, v9, v33
    v_dot2_f32_bf16 v33, v102, v10, v33
    v_dot2_f32_bf16 v33, v103, v11, v33
    buffer_load_dwordx4 v[100:103], v17, s[28:31], 0 offen offset:768
    s_waitcnt vmcnt(17)
    v_dot2_f32_bf16 v34, v104, v8, 0
    v_dot2_f32_bf16 v34, v105, v9, v34
    v_dot2_f32_bf16 v34, v106, v10, v34
    v_dot2_f32_bf16 v34, v107, v11, v34
    buffer_load_dwordx4 v[104:107], v17, s[28:31], 0 offen offset:1024
    s_waitcnt vmcnt(17)
    v_dot2_f32_bf16 v35, v108, v8, 0
    v_dot2_f32_bf16 v35, v109, v9, v35
    v_dot2_f32_bf16 v35, v110, v10, v35
    v_dot2_f32_bf16 v35, v111, v11, v35
    s_mov_b32 s86, 0x12000
    buffer_load_dwordx4 v[108:111], v17, s[28:31], s86 offen offset:0
    s_waitcnt vmcnt(17)
    v_dot2_f32_bf16 v36, v112, v8, 0
    v_dot2_f32_bf16 v36, v113, v9, v36
    v_dot2_f32_bf16 v36, v114, v10, v36
    v_dot2_f32_bf16 v36, v115, v11, v36
    buffer_load_dwordx4 v[112:115], v17, s[28:31], s86 offen offset:256
    s_waitcnt vmcnt(17)
    v_dot2_f32_bf16 v37, v116, v8, 0
    v_dot2_f32_bf16 v37, v117, v9, v37
    v_dot2_f32_bf16 v37, v118, v10, v37
    v_dot2_f32_bf16 v37, v119, v11, v37
    buffer_load_dwordx4 v[116:119], v17, s[28:31], s86 offen offset:512
    s_waitcnt vmcnt(17)
    v_dot2_f32_bf16 v38, v120, v8, 0
    v_dot2_f32_bf16 v38, v121, v9, v38
    v_dot2_f32_bf16 v38, v122, v10, v38
    v_dot2_f32_bf16 v38, v123, v11, v38
    buffer_load_dwordx4 v[120:123], v17, s[28:31], s86 offen offset:768
    s_waitcnt vmcnt(17)
    v_dot2_f32_bf16 v39, v124, v8, 0
    v_dot2_f32_bf16 v39, v125, v9, v39
    v_dot2_f32_bf16 v39, v126, v10, v39
    v_dot2_f32_bf16 v39, v127, v11, v39
    buffer_load_dwordx4 v[124:127], v17, s[28:31], s86 offen offset:1024
    v_add_f32_dpp v40, v32, v32 row_ror:8 row_mask:0xf bank_mask:0x3
    v_add_f32_dpp v40, v33, v33 row_ror:8 row_mask:0xf bank_mask:0xc
    v_add_f32_dpp v41, v34, v34 row_ror:8 row_mask:0xf bank_mask:0x3
    v_add_f32_dpp v41, v35, v35 row_ror:8 row_mask:0xf bank_mask:0xc
    v_add_f32_dpp v42, v36, v36 row_ror:8 row_mask:0xf bank_mask:0x3
    v_add_f32_dpp v42, v37, v37 row_ror:8 row_mask:0xf bank_mask:0xc
    v_add_f32_dpp v43, v38, v38 row_ror:8 row_mask:0xf bank_mask:0x3
    v_add_f32_dpp v43, v39, v39 row_ror:8 row_mask:0xf bank_mask:0xc
    v_add_f32_dpp v44, v40, v40 row_half_mirror row_mask:0xf bank_mask:0x5
    v_add_f32_dpp v44, v41, v41 row_half_mirror row_mask:0xf bank_mask:0xa
    v_add_f32_dpp v45, v42, v42 row_half_mirror row_mask:0xf bank_mask:0x5
    v_add_f32_dpp v45, v43, v43 row_half_mirror row_mask:0xf bank_mask:0xa
    v_add_f32_dpp v44, v44, v44 quad_perm:[1,0,3,2] row_mask:0xf bank_mask:0xf
    s_nop 0
    v_add_f32_dpp v45, v45, v45 quad_perm:[1,0,3,2] row_mask:0xf bank_mask:0xf
    v_add_f32_dpp v44, v44, v44 quad_perm:[2,3,0,1] row_mask:0xf bank_mask:0xf
    s_nop 0
    v_add_f32_dpp v45, v45, v45 quad_perm:[2,3,0,1] row_mask:0xf bank_mask:0xf
    v_cvt_pk_bf16_f32 v40, v44, v45
    v_lshlrev_b32 v44, 16, v40
    v_and_b32 v45, s99, v40
    v_mul_f32 v44, s96, v44
    v_mul_f32 v45, s96, v45
    v_cvt_pk_bf16_f32 v40, v44, v45
    v_lshlrev_b32 v44, 16, v40
    v_and_b32 v45, s99, v40
    v_max_f32 v46, v44, v45
    s_nop 1
    v_max_f32_dpp v46, v46, v46 row_ror:4 row_mask:0xf bank_mask:0xf
    s_nop 1
    v_max_f32_dpp v46, v46, v46 row_ror:8 row_mask:0xf bank_mask:0xf
    s_nop 0
    v_readlane_b32 s88, v46, 0
    v_readlane_b32 s89, v46, 16
    v_readlane_b32 s90, v46, 32
    v_readlane_b32 s91, v46, 48
    v_max_f32 v46, s88, v13
    v_max_f32 v46, s89, v46
    v_max_f32 v46, s90, v46
    v_max_f32 v46, s91, v46
    v_sub_f32 v47, v13, v46
    v_sub_f32 v44, v44, v46
    v_sub_f32 v45, v45, v46
    v_mul_f32 v47, s97, v47
    v_mul_f32 v44, s97, v44
    v_mul_f32 v45, s97, v45
    v_exp_f32 v47, v47
    v_exp_f32 v44, v44
    v_exp_f32 v45, v45
    v_mov_b32 v13, v46
    v_fma_f32 v14, v14, v47, v44
    v_add_f32 v14, v14, v45
    v_mul_f32 v20, v20, v47
    v_mul_f32 v21, v21, v47
    v_mul_f32 v22, v22, v47
    v_mul_f32 v23, v23, v47
    v_cvt_pk_bf16_f32 v44, v44, v44
    v_cvt_pk_bf16_f32 v45, v45, v45
    s_nop 0
    v_and_b32_dpp v24, v44, v4 row_newbcast:0 row_mask:0xf bank_mask:0xf
    v_and_b32_dpp v25, v44, v5 row_newbcast:0 row_mask:0xf bank_mask:0xf
    v_and_b32_dpp v26, v44, v6 row_newbcast:0 row_mask:0xf bank_mask:0xf
    v_and_b32_dpp v27, v44, v7 row_newbcast:0 row_mask:0xf bank_mask:0xf
    s_waitcnt vmcnt(17)
    s_nop 0
    v_mfma_f32_16x16x32_bf16 v[20:23], v[24:27], v[56:59], v[20:23]
    s_mov_b32 s86, 0x24000
    buffer_load_dwordx4 v[56:59], v17, s[28:31], s86 offen offset:0
    v_and_b32_dpp v28, v44, v4 row_newbcast:8 row_mask:0xf bank_mask:0xf
    v_and_b32_dpp v29, v44, v5 row_newbcast:8 row_mask:0xf bank_mask:0xf
    v_and_b32_dpp v30, v44, v6 row_newbcast:8 row_mask:0xf bank_mask:0xf
    v_and_b32_dpp v31, v44, v7 row_newbcast:8 row_mask:0xf bank_mask:0xf
    s_waitcnt vmcnt(17)
    s_nop 0
    v_mfma_f32_16x16x32_bf16 v[20:23], v[28:31], v[60:63], v[20:23]
    buffer_load_dwordx4 v[60:63], v17, s[28:31], s86 offen offset:256
    v_and_b32_dpp v24, v44, v4 row_newbcast:4 row_mask:0xf bank_mask:0xf
    v_and_b32_dpp v25, v44, v5 row_newbcast:4 row_mask:0xf bank_mask:0xf
    v_and_b32_dpp v26, v44, v6 row_newbcast:4 row_mask:0xf bank_mask:0xf
    v_and_b32_dpp v27, v44, v7 row_newbcast:4 row_mask:0xf bank_mask:0xf
    s_waitcnt vmcnt(17)
    s_nop 0
    v_mfma_f32_16x16x32_bf16 v[20:23], v[24:27], v[64:67], v[20:23]
    buffer_load_dwordx4 v[64:67], v17, s[28:31], s86 offen offset:512
    v_and_b32_dpp v28, v44, v4 row_newbcast:12 row_mask:0xf bank_mask:0xf
    v_and_b32_dpp v29, v44, v5 row_newbcast:12 row_mask:0xf bank_mask:0xf
    v_and_b32_dpp v30, v44, v6 row_newbcast:12 row_mask:0xf bank_mask:0xf
    v_and_b32_dpp v31, v44, v7 row_newbcast:12 row_mask:0xf bank_mask:0xf
    s_waitcnt vmcnt(17)
    s_nop 0
    v_mfma_f32_16x16x32_bf16 v[20:23], v[28:31], v[68:71], v[20:23]
    buffer_load_dwordx4 v[68:71], v17, s[28:31], s86 offen offset:768
    v_and_b32_dpp v24, v45, v4 row_newbcast:0 row_mask:0xf bank_mask:0xf
    v_and_b32_dpp v25, v45, v5 row_newbcast:0 row_mask:0xf bank_mask:0xf
    v_and_b32_dpp v26, v45, v6 row_newbcast:0 row_mask:0xf bank_mask:0xf
    v_and_b32_dpp v27, v45, v7 row_newbcast:0 row_mask:0xf bank_mask:0xf
    s_waitcnt vmcnt(17)
    s_nop 0
    v_mfma_f32_16x16x32_bf16 v[20:23], v[24:27], v[72:75], v[20:23]
    buffer_load_dwordx4 v[72:75], v17, s[28:31], s86 offen offset:1024
    v_and_b32_dpp v28, v45, v4 row_newbcast:8 row_mask:0xf bank_mask:0xf
    v_and_b32_dpp v29, v45, v5 row_newbcast:8 row_mask:0xf bank_mask:0xf
    v_and_b32_dpp v30, v45, v6 row_newbcast:8 row_mask:0xf bank_mask:0xf
    v_and_b32_dpp v31, v45, v7 row_newbcast:8 row_mask:0xf bank_mask:0xf
    s_waitcnt vmcnt(17)
    s_nop 0
    v_mfma_f32_16x16x32_bf16 v[20:23], v[28:31], v[76:79], v[20:23]
    s_add_u32 s85, s84, 0xe0000
    buffer_load_dwordx4 v[76:79], v1, s[8:11], s85 offen offset:0 nt
    v_and_b32_dpp v24, v45, v4 row_newbcast:4 row_mask:0xf bank_mask:0xf
    v_and_b32_dpp v25, v45, v5 row_newbcast:4 row_mask:0xf bank_mask:0xf
    v_and_b32_dpp v26, v45, v6 row_newbcast:4 row_mask:0xf bank_mask:0xf
    v_and_b32_dpp v27, v45, v7 row_newbcast:4 row_mask:0xf bank_mask:0xf
    s_waitcnt vmcnt(17)
    s_nop 0
    v_mfma_f32_16x16x32_bf16 v[20:23], v[24:27], v[80:83], v[20:23]
    buffer_load_dwordx4 v[80:83], v1, s[8:11], s85 offen offset:1024 nt
    v_and_b32_dpp v28, v45, v4 row_newbcast:12 row_mask:0xf bank_mask:0xf
    v_and_b32_dpp v29, v45, v5 row_newbcast:12 row_mask:0xf bank_mask:0xf
    v_and_b32_dpp v30, v45, v6 row_newbcast:12 row_mask:0xf bank_mask:0xf
    v_and_b32_dpp v31, v45, v7 row_newbcast:12 row_mask:0xf bank_mask:0xf
    s_waitcnt vmcnt(17)
    s_nop 0
    v_mfma_f32_16x16x32_bf16 v[20:23], v[28:31], v[84:87], v[20:23]
    buffer_load_dwordx4 v[84:87], v1, s[8:11], s85 offen offset:2048 nt
    s_waitcnt lgkmcnt(0)
    s_barrier
    v_lshrrev_b32 v19, 4, v2
    v_min_u32 v19, 2, v19
    v_lshl_add_u32 v19, v19, 6, v3
    s_lshl_b32 s7, s3, 2
    v_add_u32 v19, s7, v19
    v_lshlrev_b32 v19, 1, v19
    ds_read_u16 v12, v19 offset:8704
    s_waitcnt lgkmcnt(0)
    v_lshl_or_b32 v12, v12, 16, v12
    s_nop 1
    v_and_b32_dpp v24, v12, v4 row_newbcast:0 row_mask:0xf bank_mask:0xf
    v_and_b32_dpp v25, v12, v5 row_newbcast:0 row_mask:0xf bank_mask:0xf
    v_and_b32_dpp v26, v12, v6 row_newbcast:0 row_mask:0xf bank_mask:0xf
    v_and_b32_dpp v27, v12, v7 row_newbcast:0 row_mask:0xf bank_mask:0xf
    s_waitcnt vmcnt(17)
    s_nop 0
    v_mfma_f32_16x16x32_bf16 v[32:35], v[24:27], v[88:91], 0
    buffer_load_dwordx4 v[88:91], v1, s[8:11], s85 offen offset:3072 nt
    s_waitcnt vmcnt(17)
    v_mfma_f32_16x16x32_bf16 v[36:39], v[24:27], v[92:95], 0
    s_add_u32 s85, s84, 0xe1000
    buffer_load_dwordx4 v[92:95], v1, s[8:11], s85 offen offset:0 nt
    s_waitcnt vmcnt(17)
    v_mfma_f32_16x16x32_bf16 v[40:43], v[24:27], v[96:99], 0
    buffer_load_dwordx4 v[96:99], v1, s[8:11], s85 offen offset:1024 nt
    s_waitcnt vmcnt(17)
    v_mfma_f32_16x16x32_bf16 v[44:47], v[24:27], v[100:103], 0
    buffer_load_dwordx4 v[100:103], v1, s[8:11], s85 offen offset:2048 nt
    s_waitcnt vmcnt(17)
    v_mfma_f32_16x16x32_bf16 v[48:51], v[24:27], v[104:107], 0
    buffer_load_dwordx4 v[104:107], v1, s[8:11], s85 offen offset:3072 nt
    v_and_b32_dpp v28, v12, v4 row_newbcast:1 row_mask:0xf bank_mask:0xf
    v_and_b32_dpp v29, v12, v5 row_newbcast:1 row_mask:0xf bank_mask:0xf
    v_and_b32_dpp v30, v12, v6 row_newbcast:1 row_mask:0xf bank_mask:0xf
    v_and_b32_dpp v31, v12, v7 row_newbcast:1 row_mask:0xf bank_mask:0xf
    s_waitcnt vmcnt(17)
    s_nop 0
    v_mfma_f32_16x16x32_bf16 v[32:35], v[28:31], v[108:111], v[32:35]
    s_add_u32 s85, s84, 0xe0000
    buffer_load_dwordx4 v[108:111], v1, s[12:15], s85 offen offset:0 nt
    s_waitcnt vmcnt(17)
    v_mfma_f32_16x16x32_bf16 v[36:39], v[28:31], v[112:115], v[36:39]
    buffer_load_dwordx4 v[112:115], v1, s[12:15], s85 offen offset:1024 nt
    s_waitcnt vmcnt(17)
    v_mfma_f32_16x16x32_bf16 v[40:43], v[28:31], v[116:119], v[40:43]
    buffer_load_dwordx4 v[116:119], v1, s[12:15], s85 offen offset:2048 nt
    s_waitcnt vmcnt(17)
    v_mfma_f32_16x16x32_bf16 v[44:47], v[28:31], v[120:123], v[44:47]
    buffer_load_dwordx4 v[120:123], v1, s[12:15], s85 offen offset:3072 nt
    s_waitcnt vmcnt(17)
    v_mfma_f32_16x16x32_bf16 v[48:51], v[28:31], v[124:127], v[48:51]
    s_add_u32 s85, s84, 0xe1000
    buffer_load_dwordx4 v[124:127], v1, s[12:15], s85 offen offset:0 nt
    v_and_b32_dpp v24, v12, v4 row_newbcast:2 row_mask:0xf bank_mask:0xf
    v_and_b32_dpp v25, v12, v5 row_newbcast:2 row_mask:0xf bank_mask:0xf
    v_and_b32_dpp v26, v12, v6 row_newbcast:2 row_mask:0xf bank_mask:0xf
    v_and_b32_dpp v27, v12, v7 row_newbcast:2 row_mask:0xf bank_mask:0xf
    s_waitcnt vmcnt(17)
    s_nop 0
    v_mfma_f32_16x16x32_bf16 v[32:35], v[24:27], v[56:59], v[32:35]
    buffer_load_dwordx4 v[56:59], v1, s[12:15], s85 offen offset:1024 nt
    s_waitcnt vmcnt(17)
    v_mfma_f32_16x16x32_bf16 v[36:39], v[24:27], v[60:63], v[36:39]
    buffer_load_dwordx4 v[60:63], v1, s[12:15], s85 offen offset:2048 nt
    s_waitcnt vmcnt(17)
    v_mfma_f32_16x16x32_bf16 v[40:43], v[24:27], v[64:67], v[40:43]
    buffer_load_dwordx4 v[64:67], v1, s[12:15], s85 offen offset:3072 nt
    s_waitcnt vmcnt(17)
    v_mfma_f32_16x16x32_bf16 v[44:47], v[24:27], v[68:71], v[44:47]
    s_lshl_b32 s7, s3, 3
    v_add_u32 v17, s7, v3
    v_mul_u32_u24 v17, 1152, v17
    v_add_u32 v17, v17, v2
    buffer_load_dwordx4 v[68:71], v17, s[32:35], 0 offen offset:0
    s_waitcnt vmcnt(17)
    v_mfma_f32_16x16x32_bf16 v[48:51], v[24:27], v[72:75], v[48:51]
    buffer_load_dwordx4 v[72:75], v17, s[32:35], 0 offen offset:256
    s_mul_i32 s6, s3, 2560
    s_add_u32 s6, s6, 42368
    v_add_u32 v19, s6, v18
    s_mov_b32 exec_lo, -1
    s_mov_b32 exec_hi, 0
    ds_write_b128 v19, v[32:35] offset:0
    ds_write_b128 v19, v[36:39] offset:512
    ds_write_b128 v19, v[40:43] offset:1024
    ds_write_b128 v19, v[44:47] offset:1536
    ds_write_b128 v19, v[48:51] offset:2048
    s_mov_b64 exec, -1
    s_waitcnt lgkmcnt(0)
    s_barrier
    s_cmp_ge_u32 s3, 9
    s_cbranch_scc1 L_bpub_3
    s_lshl_b32 s6, s3, 8
    v_lshl_add_u32 v48, v0, 2, s6
    v_add_u32 v49, 0xa580, v48
    ds_read_b32 v32, v49 offset:0
    ds_read_b32 v33, v49 offset:2560
    ds_read_b32 v34, v49 offset:5120
    ds_read_b32 v35, v49 offset:7680
    ds_read_b32 v36, v49 offset:10240
    ds_read_b32 v37, v49 offset:12800
    ds_read_b32 v38, v49 offset:15360
    ds_read_b32 v39, v49 offset:17920
    ds_read_b32 v40, v49 offset:20480
    ds_read_b32 v41, v49 offset:23040
    ds_read_b32 v42, v49 offset:25600
    ds_read_b32 v43, v49 offset:28160
    ds_read_b32 v44, v49 offset:30720
    ds_read_b32 v45, v49 offset:33280
    ds_read_b32 v46, v49 offset:35840
    ds_read_b32 v47, v49 offset:38400
    s_waitcnt lgkmcnt(0)
    v_add_f32 v32, v32, v40
    v_add_f32 v33, v33, v41
    v_add_f32 v34, v34, v42
    v_add_f32 v35, v35, v43
    v_add_f32 v36, v36, v44
    v_add_f32 v37, v37, v45
    v_add_f32 v38, v38, v46
    v_add_f32 v39, v39, v47
    v_add_f32 v32, v32, v36
    v_add_f32 v33, v33, v37
    v_add_f32 v34, v34, v38
    v_add_f32 v35, v35, v39
    v_add_f32 v32, v32, v34
    v_add_f32 v33, v33, v35
    v_add_f32 v32, v32, v33
    v_lshlrev_b32 v48, 2, v0
    s_add_u32 s6, s98, 8192
    buffer_store_dword v32, v48, s[72:75], s6 offen sc1
L_bpub_3:
    s_waitcnt vmcnt(17)
    v_dot2_f32_bf16 v32, v76, v8, 0
    v_dot2_f32_bf16 v32, v77, v9, v32
    v_dot2_f32_bf16 v32, v78, v10, v32
    v_dot2_f32_bf16 v32, v79, v11, v32
    buffer_load_dwordx4 v[76:79], v17, s[32:35], 0 offen offset:512
    s_waitcnt vmcnt(17)
    v_dot2_f32_bf16 v33, v80, v8, 0
    v_dot2_f32_bf16 v33, v81, v9, v33
    v_dot2_f32_bf16 v33, v82, v10, v33
    v_dot2_f32_bf16 v33, v83, v11, v33
    buffer_load_dwordx4 v[80:83], v17, s[32:35], 0 offen offset:768
    s_waitcnt vmcnt(17)
    v_dot2_f32_bf16 v34, v84, v8, 0
    v_dot2_f32_bf16 v34, v85, v9, v34
    v_dot2_f32_bf16 v34, v86, v10, v34
    v_dot2_f32_bf16 v34, v87, v11, v34
    buffer_load_dwordx4 v[84:87], v17, s[32:35], 0 offen offset:1024
    s_waitcnt vmcnt(17)
    v_dot2_f32_bf16 v35, v88, v8, 0
    v_dot2_f32_bf16 v35, v89, v9, v35
    v_dot2_f32_bf16 v35, v90, v10, v35
    v_dot2_f32_bf16 v35, v91, v11, v35
    s_mov_b32 s86, 0x1200
    buffer_load_dwordx4 v[88:91], v17, s[32:35], s86 offen offset:0
    s_waitcnt vmcnt(17)
    v_dot2_f32_bf16 v36, v92, v8, 0
    v_dot2_f32_bf16 v36, v93, v9, v36
    v_dot2_f32_bf16 v36, v94, v10, v36
    v_dot2_f32_bf16 v36, v95, v11, v36
    buffer_load_dwordx4 v[92:95], v17, s[32:35], s86 offen offset:256
    s_waitcnt vmcnt(17)
    v_dot2_f32_bf16 v37, v96, v8, 0
    v_dot2_f32_bf16 v37, v97, v9, v37
    v_dot2_f32_bf16 v37, v98, v10, v37
    v_dot2_f32_bf16 v37, v99, v11, v37
    buffer_load_dwordx4 v[96:99], v17, s[32:35], s86 offen offset:512
    s_waitcnt vmcnt(17)
    v_dot2_f32_bf16 v38, v100, v8, 0
    v_dot2_f32_bf16 v38, v101, v9, v38
    v_dot2_f32_bf16 v38, v102, v10, v38
    v_dot2_f32_bf16 v38, v103, v11, v38
    buffer_load_dwordx4 v[100:103], v17, s[32:35], s86 offen offset:768
    s_waitcnt vmcnt(17)
    v_dot2_f32_bf16 v39, v104, v8, 0
    v_dot2_f32_bf16 v39, v105, v9, v39
    v_dot2_f32_bf16 v39, v106, v10, v39
    v_dot2_f32_bf16 v39, v107, v11, v39
    buffer_load_dwordx4 v[104:107], v17, s[32:35], s86 offen offset:1024
    v_add_f32_dpp v40, v32, v32 row_ror:8 row_mask:0xf bank_mask:0x3
    v_add_f32_dpp v40, v33, v33 row_ror:8 row_mask:0xf bank_mask:0xc
    v_add_f32_dpp v41, v34, v34 row_ror:8 row_mask:0xf bank_mask:0x3
    v_add_f32_dpp v41, v35, v35 row_ror:8 row_mask:0xf bank_mask:0xc
    v_add_f32_dpp v42, v36, v36 row_ror:8 row_mask:0xf bank_mask:0x3
    v_add_f32_dpp v42, v37, v37 row_ror:8 row_mask:0xf bank_mask:0xc
    v_add_f32_dpp v43, v38, v38 row_ror:8 row_mask:0xf bank_mask:0x3
    v_add_f32_dpp v43, v39, v39 row_ror:8 row_mask:0xf bank_mask:0xc
    v_add_f32_dpp v44, v40, v40 row_half_mirror row_mask:0xf bank_mask:0x5
    v_add_f32_dpp v44, v41, v41 row_half_mirror row_mask:0xf bank_mask:0xa
    v_add_f32_dpp v45, v42, v42 row_half_mirror row_mask:0xf bank_mask:0x5
    v_add_f32_dpp v45, v43, v43 row_half_mirror row_mask:0xf bank_mask:0xa
    v_add_f32_dpp v44, v44, v44 quad_perm:[1,0,3,2] row_mask:0xf bank_mask:0xf
    s_nop 0
    v_add_f32_dpp v45, v45, v45 quad_perm:[1,0,3,2] row_mask:0xf bank_mask:0xf
    v_add_f32_dpp v44, v44, v44 quad_perm:[2,3,0,1] row_mask:0xf bank_mask:0xf
    s_nop 0
    v_add_f32_dpp v45, v45, v45 quad_perm:[2,3,0,1] row_mask:0xf bank_mask:0xf
    v_cvt_pk_bf16_f32 v40, v44, v45
    v_lshlrev_b32 v44, 16, v40
    v_and_b32 v45, s99, v40
    v_mul_f32 v44, s96, v44
    v_mul_f32 v45, s96, v45
    v_cvt_pk_bf16_f32 v40, v44, v45
    v_lshlrev_b32 v44, 16, v40
    v_and_b32 v45, s99, v40
    v_max_f32 v46, v44, v45
    s_nop 1
    v_max_f32_dpp v46, v46, v46 row_ror:4 row_mask:0xf bank_mask:0xf
    s_nop 1
    v_max_f32_dpp v46, v46, v46 row_ror:8 row_mask:0xf bank_mask:0xf
    s_nop 0
    v_readlane_b32 s88, v46, 0
    v_readlane_b32 s89, v46, 16
    v_readlane_b32 s90, v46, 32
    v_readlane_b32 s91, v46, 48
    v_max_f32 v46, s88, v13
    v_max_f32 v46, s89, v46
    v_max_f32 v46, s90, v46
    v_max_f32 v46, s91, v46
    v_sub_f32 v47, v13, v46
    v_sub_f32 v44, v44, v46
    v_sub_f32 v45, v45, v46
    v_mul_f32 v47, s97, v47
    v_mul_f32 v44, s97, v44
    v_mul_f32 v45, s97, v45
    v_exp_f32 v47, v47
    v_exp_f32 v44, v44
    v_exp_f32 v45, v45
    v_mov_b32 v13, v46
    v_fma_f32 v14, v14, v47, v44
    v_add_f32 v14, v14, v45
    v_mul_f32 v20, v20, v47
    v_mul_f32 v21, v21, v47
    v_mul_f32 v22, v22, v47
    v_mul_f32 v23, v23, v47
    v_cvt_pk_bf16_f32 v44, v44, v44
    v_cvt_pk_bf16_f32 v45, v45, v45
    s_nop 0
    v_and_b32_dpp v24, v44, v4 row_newbcast:0 row_mask:0xf bank_mask:0xf
    v_and_b32_dpp v25, v44, v5 row_newbcast:0 row_mask:0xf bank_mask:0xf
    v_and_b32_dpp v26, v44, v6 row_newbcast:0 row_mask:0xf bank_mask:0xf
    v_and_b32_dpp v27, v44, v7 row_newbcast:0 row_mask:0xf bank_mask:0xf
    s_waitcnt vmcnt(17)
    s_nop 0
    v_mfma_f32_16x16x32_bf16 v[20:23], v[24:27], v[108:111], v[20:23]
    v_and_b32_dpp v28, v44, v4 row_newbcast:8 row_mask:0xf bank_mask:0xf
    v_and_b32_dpp v29, v44, v5 row_newbcast:8 row_mask:0xf bank_mask:0xf
    v_and_b32_dpp v30, v44, v6 row_newbcast:8 row_mask:0xf bank_mask:0xf
    v_and_b32_dpp v31, v44, v7 row_newbcast:8 row_mask:0xf bank_mask:0xf
    s_waitcnt vmcnt(16)
    s_nop 0
    v_mfma_f32_16x16x32_bf16 v[20:23], v[28:31], v[112:115], v[20:23]
    v_and_b32_dpp v24, v44, v4 row_newbcast:4 row_mask:0xf bank_mask:0xf
    v_and_b32_dpp v25, v44, v5 row_newbcast:4 row_mask:0xf bank_mask:0xf
    v_and_b32_dpp v26, v44, v6 row_newbcast:4 row_mask:0xf bank_mask:0xf
    v_and_b32_dpp v27, v44, v7 row_newbcast:4 row_mask:0xf bank_mask:0xf
    s_waitcnt vmcnt(15)
    s_nop 0
    v_mfma_f32_16x16x32_bf16 v[20:23], v[24:27], v[116:119], v[20:23]
    v_and_b32_dpp v28, v44, v4 row_newbcast:12 row_mask:0xf bank_mask:0xf
    v_and_b32_dpp v29, v44, v5 row_newbcast:12 row_mask:0xf bank_mask:0xf
    v_and_b32_dpp v30, v44, v6 row_newbcast:12 row_mask:0xf bank_mask:0xf
    v_and_b32_dpp v31, v44, v7 row_newbcast:12 row_mask:0xf bank_mask:0xf
    s_waitcnt vmcnt(14)
    s_nop 0
    v_mfma_f32_16x16x32_bf16 v[20:23], v[28:31], v[120:123], v[20:23]
    v_and_b32_dpp v24, v45, v4 row_newbcast:0 row_mask:0xf bank_mask:0xf
    v_and_b32_dpp v25, v45, v5 row_newbcast:0 row_mask:0xf bank_mask:0xf
    v_and_b32_dpp v26, v45, v6 row_newbcast:0 row_mask:0xf bank_mask:0xf
    v_and_b32_dpp v27, v45, v7 row_newbcast:0 row_mask:0xf bank_mask:0xf
    s_waitcnt vmcnt(13)
    s_nop 0
    v_mfma_f32_16x16x32_bf16 v[20:23], v[24:27], v[124:127], v[20:23]
    v_and_b32_dpp v28, v45, v4 row_newbcast:8 row_mask:0xf bank_mask:0xf
    v_and_b32_dpp v29, v45, v5 row_newbcast:8 row_mask:0xf bank_mask:0xf
    v_and_b32_dpp v30, v45, v6 row_newbcast:8 row_mask:0xf bank_mask:0xf
    v_and_b32_dpp v31, v45, v7 row_newbcast:8 row_mask:0xf bank_mask:0xf
    s_waitcnt vmcnt(12)
    s_nop 0
    v_mfma_f32_16x16x32_bf16 v[20:23], v[28:31], v[56:59], v[20:23]
    v_and_b32_dpp v24, v45, v4 row_newbcast:4 row_mask:0xf bank_mask:0xf
    v_and_b32_dpp v25, v45, v5 row_newbcast:4 row_mask:0xf bank_mask:0xf
    v_and_b32_dpp v26, v45, v6 row_newbcast:4 row_mask:0xf bank_mask:0xf
    v_and_b32_dpp v27, v45, v7 row_newbcast:4 row_mask:0xf bank_mask:0xf
    s_waitcnt vmcnt(11)
    s_nop 0
    v_mfma_f32_16x16x32_bf16 v[20:23], v[24:27], v[60:63], v[20:23]
    v_and_b32_dpp v28, v45, v4 row_newbcast:12 row_mask:0xf bank_mask:0xf
    v_and_b32_dpp v29, v45, v5 row_newbcast:12 row_mask:0xf bank_mask:0xf
    v_and_b32_dpp v30, v45, v6 row_newbcast:12 row_mask:0xf bank_mask:0xf
    v_and_b32_dpp v31, v45, v7 row_newbcast:12 row_mask:0xf bank_mask:0xf
    s_waitcnt vmcnt(10)
    s_nop 0
    v_mfma_f32_16x16x32_bf16 v[20:23], v[28:31], v[64:67], v[20:23]
    v_add_f32_dpp v14, v14, v14 row_ror:4 row_mask:0xf bank_mask:0xf
    s_nop 1
    v_add_f32_dpp v14, v14, v14 row_ror:8 row_mask:0xf bank_mask:0xf
    s_nop 0
    v_readlane_b32 s88, v14, 0
    v_readlane_b32 s89, v14, 16
    v_readlane_b32 s90, v14, 32
    v_readlane_b32 s91, v14, 48
    v_mov_b32 v14, s88
    v_add_f32 v14, s89, v14
    v_add_f32 v14, s90, v14
    v_add_f32 v14, s91, v14
    s_mul_i32 s6, s3, 528
    v_add_u32 v19, s6, v18
    s_mov_b32 exec_lo, -1
    s_mov_b32 exec_hi, 0
    ds_write_b128 v19, v[20:23] offset:9216
    s_mov_b32 exec_lo, 1
    s_lshl_b32 s6, s3, 3
    v_mov_b32 v19, s6
    v_mov_b32 v48, v13
    v_mov_b32 v49, v14
    ds_write_b64 v19, v[48:49] offset:17664
    s_mov_b64 exec, -1
    s_waitcnt lgkmcnt(0)
    s_barrier
    v_lshrrev_b32 v19, 1, v2
    ds_read_b64 v[48:49], v19 offset:17664
    v_lshrrev_b32 v19, 4, v2
    v_mul_u32_u24 v19, 528, v19
    v_lshl_add_u32 v19, v3, 2, v19
    s_lshl_b32 s6, s3, 5
    v_add_u32 v19, s6, v19
    ds_read_b32 v52, v19 offset:9216
    ds_read_b32 v53, v19 offset:9232
    s_waitcnt lgkmcnt(0)
    v_mov_b32 v50, v48
    s_nop 1
    v_max_f32_dpp v50, v50, v50 row_ror:1 row_mask:0xf bank_mask:0xf
    s_nop 1
    v_max_f32_dpp v50, v50, v50 row_ror:2 row_mask:0xf bank_mask:0xf
    s_nop 1
    v_max_f32_dpp v50, v50, v50 row_ror:4 row_mask:0xf bank_mask:0xf
    s_nop 1
    v_max_f32_dpp v50, v50, v50 row_ror:8 row_mask:0xf bank_mask:0xf
    v_sub_f32 v48, v48, v50
    v_mul_f32 v48, s97, v48
    v_exp_f32 v48, v48
    s_nop 0
    v_mul_f32 v49, v49, v48
    v_mul_f32 v52, v52, v48
    v_mul_f32 v53, v53, v48
    v_add_f32_dpp v49, v49, v49 row_ror:1 row_mask:0xf bank_mask:0xf
    v_add_f32_dpp v52, v52, v52 row_ror:1 row_mask:0xf bank_mask:0xf
    v_add_f32_dpp v53, v53, v53 row_ror:1 row_mask:0xf bank_mask:0xf
    v_add_f32_dpp v49, v49, v49 row_ror:2 row_mask:0xf bank_mask:0xf
    v_add_f32_dpp v52, v52, v52 row_ror:2 row_mask:0xf bank_mask:0xf
    v_add_f32_dpp v53, v53, v53 row_ror:2 row_mask:0xf bank_mask:0xf
    v_add_f32_dpp v49, v49, v49 row_ror:4 row_mask:0xf bank_mask:0xf
    v_add_f32_dpp v52, v52, v52 row_ror:4 row_mask:0xf bank_mask:0xf
    v_add_f32_dpp v53, v53, v53 row_ror:4 row_mask:0xf bank_mask:0xf
    v_add_f32_dpp v49, v49, v49 row_ror:8 row_mask:0xf bank_mask:0xf
    v_add_f32_dpp v52, v52, v52 row_ror:8 row_mask:0xf bank_mask:0xf
    v_add_f32_dpp v53, v53, v53 row_ror:8 row_mask:0xf bank_mask:0xf
    v_rcp_f32 v49, v49
    s_nop 0
    v_mul_f32 v52, v52, v49
    v_mul_f32 v53, v53, v49
    v_cvt_pk_bf16_f32 v52, v52, v52
    v_cvt_pk_bf16_f32 v53, v53, v53
    v_and_b32 v24, v52, v4
    v_and_b32 v25, v52, v5
    v_and_b32 v26, v52, v6
    v_and_b32 v27, v52, v7
    v_and_b32 v28, v53, v4
    v_and_b32 v29, v53, v5
    v_and_b32 v30, v53, v6
    v_and_b32 v31, v53, v7
    s_waitcnt vmcnt(9)
    v_mfma_f32_16x16x32_bf16 v[32:35], v[24:27], v[68:71], 0
    s_waitcnt vmcnt(8)
    v_mfma_f32_16x16x32_bf16 v[36:39], v[24:27], v[72:75], 0
    s_waitcnt vmcnt(7)
    v_mfma_f32_16x16x32_bf16 v[40:43], v[24:27], v[76:79], 0
    s_waitcnt vmcnt(6)
    v_mfma_f32_16x16x32_bf16 v[44:47], v[24:27], v[80:83], 0
    s_waitcnt vmcnt(5)
    v_mfma_f32_16x16x32_bf16 v[48:51], v[24:27], v[84:87], 0
    s_waitcnt vmcnt(4)
    v_mfma_f32_16x16x32_bf16 v[32:35], v[28:31], v[88:91], v[32:35]
    s_waitcnt vmcnt(3)
    v_mfma_f32_16x16x32_bf16 v[36:39], v[28:31], v[92:95], v[36:39]
    s_waitcnt vmcnt(2)
    v_mfma_f32_16x16x32_bf16 v[40:43], v[28:31], v[96:99], v[40:43]
    s_waitcnt vmcnt(1)
    v_mfma_f32_16x16x32_bf16 v[44:47], v[28:31], v[100:103], v[44:47]
    s_waitcnt vmcnt(0)
    v_mfma_f32_16x16x32_bf16 v[48:51], v[28:31], v[104:107], v[48:51]
    s_mul_i32 s6, s3, 2560
    s_add_u32 s6, s6, 83328
    v_add_u32 v19, s6, v18
    s_mov_b32 exec_lo, -1
    s_mov_b32 exec_hi, 0
    ds_write_b128 v19, v[32:35] offset:0
    ds_write_b128 v19, v[36:39] offset:512
    ds_write_b128 v19, v[40:43] offset:1024
    ds_write_b128 v19, v[44:47] offset:1536
    ds_write_b128 v19, v[48:51] offset:2048
    s_mov_b64 exec, -1
    s_waitcnt lgkmcnt(0)
    s_barrier
    s_cmp_ge_u32 s3, 9
    s_cbranch_scc1 L_done
    s_lshl_b32 s6, s3, 8
    v_lshl_add_u32 v48, v0, 2, s6
    v_add_u32 v49, 0x14580, v48
    ds_read_b32 v32, v49 offset:0
    ds_read_b32 v33, v49 offset:2560
    ds_read_b32 v34, v49 offset:5120
    ds_read_b32 v35, v49 offset:7680
    ds_read_b32 v36, v49 offset:10240
    ds_read_b32 v37, v49 offset:12800
    ds_read_b32 v38, v49 offset:15360
    ds_read_b32 v39, v49 offset:17920
    ds_read_b32 v40, v49 offset:20480
    ds_read_b32 v41, v49 offset:23040
    ds_read_b32 v42, v49 offset:25600
    ds_read_b32 v43, v49 offset:28160
    ds_read_b32 v44, v49 offset:30720
    ds_read_b32 v45, v49 offset:33280
    ds_read_b32 v46, v49 offset:35840
    ds_read_b32 v47, v49 offset:38400
    s_waitcnt lgkmcnt(0)
    v_add_f32 v32, v32, v40
    v_add_f32 v33, v33, v41
    v_add_f32 v34, v34, v42
    v_add_f32 v35, v35, v43
    v_add_f32 v36, v36, v44
    v_add_f32 v37, v37, v45
    v_add_f32 v38, v38, v46
    v_add_f32 v39, v39, v47
    v_add_f32 v32, v32, v36
    v_add_f32 v33, v33, v37
    v_add_f32 v34, v34, v38
    v_add_f32 v35, v35, v39
    v_add_f32 v32, v32, v34
    v_add_f32 v33, v33, v35
    v_add_f32 v32, v32, v33
    v_lshlrev_b32 v48, 2, v0
    s_add_u32 s6, s98, 0
    buffer_store_dword v32, v48, s[72:75], s6 offen sc1
    s_waitcnt vmcnt(0)
    v_mov_b32 v48, 1
    v_mov_b32 v49, 0
    s_mov_b32 exec_lo, 1
    s_mov_b32 exec_hi, 0
    ds_add_rtn_u32 v50, v49, v48 offset:8448
    s_waitcnt lgkmcnt(0)
    v_readfirstlane_b32 s7, v50
    s_nop 3
    s_cmp_lg_u32 s7, 8
    s_cbranch_scc1 L_arw
    s_lshl_b32 s6, s4, 4
    v_mov_b32 v50, s6
    buffer_atomic_add v48, v50, s[80:83], 0 offen sc0
    s_waitcnt vmcnt(0)
    v_add_u32 v48, 1, v48
    ds_write_b32 v49, v48 offset:8452
L_arw:
    ds_read_b32 v50, v49 offset:8452
    s_waitcnt lgkmcnt(0)
    v_readfirstlane_b32 s92, v50
    s_nop 3
    s_cmp_eq_u32 s92, 0
    s_cbranch_scc1 L_arw
    s_mov_b64 exec, -1
    s_cmp_lg_u32 s92, 32
    s_cbranch_scc1 L_done
    s_lshl_b32 s6, s94, 14
    v_lshlrev_b32 v48, 4, v0
    s_add_u32 s7, s6, 0
    buffer_load_dwordx4 v[56:59], v48, s[72:75], s7 offen offset:0 sc1
    buffer_load_dwordx4 v[60:63], v48, s[72:75], s7 offen offset:1024 sc1
    buffer_load_dwordx4 v[64:67], v48, s[72:75], s7 offen offset:2048 sc1
    buffer_load_dwordx4 v[68:71], v48, s[72:75], s7 offen offset:3072 sc1
    s_add_u32 s7, s6, 4096
    buffer_load_dwordx4 v[72:75], v48, s[72:75], s7 offen offset:0 sc1
    buffer_load_dwordx4 v[76:79], v48, s[72:75], s7 offen offset:1024 sc1
    buffer_load_dwordx4 v[80:83], v48, s[72:75], s7 offen offset:2048 sc1
    buffer_load_dwordx4 v[84:87], v48, s[72:75], s7 offen offset:3072 sc1
    s_add_u32 s7, s6, 8192
    buffer_load_dwordx4 v[88:91], v48, s[72:75], s7 offen offset:0 sc1
    buffer_load_dwordx4 v[92:95], v48, s[72:75], s7 offen offset:1024 sc1
    buffer_load_dwordx4 v[96:99], v48, s[72:75], s7 offen offset:2048 sc1
    buffer_load_dwordx4 v[100:103], v48, s[72:75], s7 offen offset:3072 sc1
    s_add_u32 s7, s6, 12288
    buffer_load_dwordx4 v[104:107], v48, s[72:75], s7 offen offset:0 sc1
    buffer_load_dwordx4 v[108:111], v48, s[72:75], s7 offen offset:1024 sc1
    buffer_load_dwordx4 v[112:115], v48, s[72:75], s7 offen offset:2048 sc1
    buffer_load_dwordx4 v[116:119], v48, s[72:75], s7 offen offset:3072 sc1
    s_waitcnt vmcnt(8)
    v_add_f32 v56, v56, v72
    v_add_f32 v57, v57, v73
    v_add_f32 v58, v58, v74
    v_add_f32 v59, v59, v75
    v_add_f32 v60, v60, v76
    v_add_f32 v61, v61, v77
    v_add_f32 v62, v62, v78
    v_add_f32 v63, v63, v79
    v_add_f32 v64, v64, v80
    v_add_f32 v65, v65, v81
    v_add_f32 v66, v66, v82
    v_add_f32 v67, v67, v83
    v_add_f32 v68, v68, v84
    v_add_f32 v69, v69, v85
    v_add_f32 v70, v70, v86
    v_add_f32 v71, v71, v87
    v_add_f32 v56, v56, v64
    v_add_f32 v57, v57, v65
    v_add_f32 v58, v58, v66
    v_add_f32 v59, v59, v67
    v_add_f32 v60, v60, v68
    v_add_f32 v61, v61, v69
    v_add_f32 v62, v62, v70
    v_add_f32 v63, v63, v71
    v_add_f32 v56, v56, v60
    v_add_f32 v57, v57, v61
    v_add_f32 v58, v58, v62
    v_add_f32 v59, v59, v63
    s_nop 0
    v_permlane32_swap_b32 v56, v58
    v_permlane32_swap_b32 v57, v59
    v_add_f32 v56, v56, v58
    v_add_f32 v57, v57, v59
    s_nop 1
    v_permlane16_swap_b32 v56, v57
    v_add_f32 v56, v56, v57
    s_waitcnt vmcnt(0)
    v_add_f32 v88, v88, v104
    v_add_f32 v89, v89, v105
    v_add_f32 v90, v90, v106
    v_add_f32 v91, v91, v107
    v_add_f32 v92, v92, v108
    v_add_f32 v93, v93, v109
    v_add_f32 v94, v94, v110
    v_add_f32 v95, v95, v111
    v_add_f32 v96, v96, v112
    v_add_f32 v97, v97, v113
    v_add_f32 v98, v98, v114
    v_add_f32 v99, v99, v115
    v_add_f32 v100, v100, v116
    v_add_f32 v101, v101, v117
    v_add_f32 v102, v102, v118
    v_add_f32 v103, v103, v119
    v_add_f32 v88, v88, v96
    v_add_f32 v89, v89, v97
    v_add_f32 v90, v90, v98
    v_add_f32 v91, v91, v99
    v_add_f32 v92, v92, v100
    v_add_f32 v93, v93, v101
    v_add_f32 v94, v94, v102
    v_add_f32 v95, v95, v103
    v_add_f32 v88, v88, v92
    v_add_f32 v89, v89, v93
    v_add_f32 v90, v90, v94
    v_add_f32 v91, v91, v95
    s_nop 0
    v_permlane32_swap_b32 v88, v90
    v_permlane32_swap_b32 v89, v91
    v_add_f32 v88, v88, v90
    v_add_f32 v89, v89, v91
    s_nop 1
    v_permlane16_swap_b32 v88, v89
    v_add_f32 v88, v88, v89
    v_cvt_pk_bf16_f32 v49, v56, v88
    v_lshlrev_b32 v56, 16, v49
    v_and_b32 v88, s99, v49
    v_mul_f32 v56, v56, v15
    v_mul_f32 v88, v88, v16
    v_cvt_pk_bf16_f32 v49, v56, v88
    v_lshlrev_b32 v56, 16, v49
    v_and_b32 v88, s99, v49
    v_add_f32 v56, v56, v88
    v_cvt_pk_bf16_f32 v56, v56, v56
    s_mul_i32 s6, s4, 576
    s_lshl_b32 s7, s3, 6
    s_add_u32 s6, s6, s7
    v_lshrrev_b32 v48, 2, v2
    v_add3_u32 v48, v48, v3, s6
    v_lshlrev_b32 v48, 1, v48
    buffer_store_short v56, v48, s[76:79], 0 offen
L_done:
    s_endpgm
.section .rodata,"a"
.p2align 6
.amdhsa_kernel gated_mix__mha_block_cached__glu_gated_geglu__decode_kernel
  .amdhsa_next_free_vgpr 128
  .amdhsa_next_free_sgpr 102
  .amdhsa_accum_offset 128
  .amdhsa_group_segment_fixed_size 0
  .amdhsa_kernarg_size 104
  .amdhsa_user_sgpr_count 2
  .amdhsa_user_sgpr_kernarg_segment_ptr 1
  .amdhsa_system_sgpr_workgroup_id_x 1
.end_amdhsa_kernel
```
